```python
import torch

def _softmax(x, axis=-1):
    return torch.softmax(x, dim=axis)
def _gelu(x):
    return torch.nn.functional.gelu(x, approximate="tanh")
def _silu(x):
    return torch.nn.functional.silu(x)
def _sigmoid(x):
    return torch.sigmoid(x)
def _layernorm(x, axis=-1, eps=1e-5):
    m = x.mean(dim=axis, keepdim=True)
    v = x.var(dim=axis, keepdim=True, unbiased=False)
    return (x - m) / torch.sqrt(v + eps)
def _scatter_add(tgt, idx, src, axis=0):
    return tgt.clone().index_add_(axis, idx, src)
def _segment_sum(src, seg, n):
    out = torch.zeros((n,) + src.shape[1:], dtype=src.dtype)
    return out.index_add_(0, seg, src)
def _pad(x, pw):
    flat = tuple(v for pair in reversed(pw) for v in pair)
    return torch.nn.functional.pad(x, flat)

kernel_name = 'concat_heads__gqa_block_cached__mha_block_cached__near_ridge'

def setup_inputs():

    _w = (lambda a: (lambda t: t.to(torch.bfloat16) if t.is_floating_point() else t)(torch.as_tensor(a)))
    def _A_setup():
        B, Sq, D = 8, 64, 512
        Hq, Hkv, Sk, Dh = 32, 8, 1024, 128
        assert Hq % Hkv == 0, (Hq, Hkv)
        return {
            "x": _w((lambda *s: torch.randn(*s, dtype=torch.bfloat16) * 0.8)(B, Sq, D)),
            "k_cache": _w((lambda *s: torch.randn(*s, dtype=torch.bfloat16) * 0.8)(B, Hkv, Sk, Dh)),
            "v_cache": _w((lambda *s: torch.randn(*s, dtype=torch.bfloat16) * 0.05)(B, Hkv, Sk, Dh)),
            "wq": _w((lambda *s: torch.randn(*s, dtype=torch.bfloat16) * 0.8)(D, Hq * Dh) * (D ** -0.5)),
            "wo": _w((lambda *s: torch.randn(*s, dtype=torch.bfloat16) * 0.05)(Hq * Dh, D) * ((Hq * Dh) ** -0.5)),
        }
    _A_in = _A_setup()

    def _B_setup():
        B, Sq, D = 8, 64, 512
        H, Sk, Dh = 32, 1024, 128
        return {
            "x": _w((lambda *s: torch.randn(*s, dtype=torch.bfloat16) * 0.8)(B, Sq, D)),
            "k_cache": _w((lambda *s: torch.randn(*s, dtype=torch.bfloat16) * 0.8)(B, H, Sk, Dh)),
            "v_cache": _w((lambda *s: torch.randn(*s, dtype=torch.bfloat16) * 0.05)(B, H, Sk, Dh)),
            "wq": _w((lambda *s: torch.randn(*s, dtype=torch.bfloat16) * 0.8)(D, H * Dh) * (D ** -0.5)),
            "wo": _w((lambda *s: torch.randn(*s, dtype=torch.bfloat16) * 0.05)(H * Dh, D) * ((H * Dh) ** -0.5)),
        }
    _B_in = _B_setup()

    return {
        "A_x": _A_in["x"],
        "A_k_cache": _A_in["k_cache"],
        "A_v_cache": _A_in["v_cache"],
        "A_wq": _A_in["wq"],
        "A_wo": _A_in["wo"],
        "B_x": _B_in["x"],
        "B_k_cache": _B_in["k_cache"],
        "B_v_cache": _B_in["v_cache"],
        "B_wq": _B_in["wq"],
        "B_wo": _B_in["wo"],
    }

def reference(A_x, A_k_cache, A_v_cache, A_wq, A_wo, B_x, B_k_cache, B_v_cache, B_wq, B_wo):
    def _A_ref(x, k_cache, v_cache, wq, wo):
        B, Sq, D = x.shape
        Hq, Dh = 32, 128
        Hkv = k_cache.shape[1]
        rep = Hq // Hkv
        q = (lambda x, *d: x.permute(*d))((x @ wq).reshape(B, Sq, Hq, Dh), 0, 2, 1, 3)
        k = (lambda x, n, axis: torch.repeat_interleave(x, n, dim=axis))(k_cache, rep, axis=1)
        v = (lambda x, n, axis: torch.repeat_interleave(x, n, dim=axis))(v_cache, rep, axis=1)
        scores = torch.einsum("bhqd,bhkd->bhqk", q, k) * (Dh ** -0.5)
        p = _softmax(scores, axis=-1)
        o = torch.einsum("bhqk,bhkd->bhqd", p, v)
        return (lambda x, *d: x.permute(*d))(o, 0, 2, 1, 3).reshape(B, Sq, Hq * Dh) @ wo

    def _B_ref(x, k_cache, v_cache, wq, wo):
        B, Sq, D = x.shape
        H, Dh = 32, 128
        q = (lambda x, *d: x.permute(*d))((x @ wq).reshape(B, Sq, H, Dh), 0, 2, 1, 3)
        scores = torch.einsum("bhqd,bhkd->bhqk", q, k_cache) * (Dh ** -0.5)
        p = _softmax(scores, axis=-1)
        o = torch.einsum("bhqk,bhkd->bhqd", p, v_cache)
        return (lambda x, *d: x.permute(*d))(o, 0, 2, 1, 3).reshape(B, Sq, H * Dh) @ wo

    a = _A_ref(A_x, A_k_cache, A_v_cache, A_wq, A_wo)
    b = _B_ref(B_x, B_k_cache, B_v_cache, B_wq, B_wo)
    return torch.concatenate([a, b], axis=-1)
```

```asm
; @launch grid=(256,1,1) block=(512,1,1) lds=163840
.amdgcn_target "amdgcn-amd-amdhsa--gfx950"
.text
.globl concat_heads__gqa_block_cached__mha_block_cached__near_ridge_kernel
.p2align 8
.type concat_heads__gqa_block_cached__mha_block_cached__near_ridge_kernel,@function
concat_heads__gqa_block_cached__mha_block_cached__near_ridge_kernel:
L_code_begin:
    s_cmp_ge_u32 s2, 256
    s_cbranch_scc1 L_end
    s_load_dwordx16 s[4:19], s[0:1], 0
    s_load_dwordx8 s[20:27], s[0:1], 64
    s_load_dwordx2 s[28:29], s[0:1], 96
    v_and_b32 v1, 63, v0
    v_lshrrev_b32 v40, 6, v0
    s_and_b32 s80, s2, 7
    v_readfirstlane_b32 s84, v40
    s_bfe_u32 s81, s2, 0x20003
    s_bfe_u32 s82, s2, 0x10005
    s_lshr_b32 s101, s84, 2
    s_and_b32 s84, s84, 3
    s_lshl_b32 s100, s101, 8
    s_and_b32 s94, s2, 0xc7
    s_add_u32 s100, s100, s94
    s_lshl_b32 s94, s81, 3
    s_add_u32 s100, s100, s94
    s_lshl_b32 s94, s82, 5
    s_add_u32 s100, s100, s94
    s_xor_b32 s82, s82, 1
    s_lshr_b32 s83, s100, 6
    s_and_b32 s85, s84, 1
    s_lshr_b32 s86, s84, 1
    v_lshlrev_b32 v27, 4, v1
    s_waitcnt lgkmcnt(0)
    s_cmp_eq_u32 s82, 1
    s_cselect_b64 s[4:5], s[14:15], s[4:5]
    s_cselect_b64 s[6:7], s[16:17], s[6:7]
    s_cselect_b64 s[8:9], s[18:19], s[8:9]
    s_cselect_b64 s[10:11], s[20:21], s[10:11]
    s_cselect_b64 s[12:13], s[22:23], s[12:13]
    s_lshl_b32 s23, s85, 13
    s_lshl_b32 s17, s84, 12
    s_mul_i32 s16, s101, 81920
    s_add_u32 s98, s17, s16
    s_lshl_b32 s3, s83, 1
    s_add_u32 s3, s3, s80
    s_mul_i32 s94, s81, 4
    s_mul_i32 s94, s94, s82
    s_add_u32 s3, s3, s94
    s_and_b32 s3, s3, 15
    s_lshl_b32 s3, s3, 14
    s_lshl_b32 s97, s80, 2
    s_add_u32 s97, s97, s81
    s_lshl_b32 s94, s83, 16
    s_add_u32 s32, s4, s94
    s_addc_u32 s33, s5, 0
    s_mov_b32 s34, 0x10000
    s_mov_b32 s35, 0x00020000
    s_lshl_b32 s94, s97, 8
    s_add_u32 s36, s10, s94
    s_addc_u32 s37, s11, 0
    s_mov_b32 s38, 0x3fe100
    s_mov_b32 s39, 0x00020000
    v_lshrrev_b32 v40, 4, v1
    v_and_b32 v41, 15, v1
    v_lshlrev_b32 v42, 2, v40
    v_xor_b32 v41, v41, v42
    s_lshl_b32 s94, s84, 14
    s_lshl_b32 s95, s84, 17
    v_xor_b32 v32, 0, v41
    v_lshlrev_b32 v32, 4, v32
    v_lshl_add_u32 v10, v40, 10, v32
    v_add_u32 v10, s94, v10
    v_lshl_add_u32 v14, v40, 13, v32
    v_add_u32 v14, s95, v14
    v_xor_b32 v33, 1, v41
    v_lshlrev_b32 v33, 4, v33
    v_lshl_add_u32 v11, v40, 10, v33
    v_add_u32 v11, s94, v11
    v_add_u32 v11, 3072, v11
    v_lshl_add_u32 v15, v40, 13, v33
    v_add_u32 v15, s95, v15
    v_add_u32 v15, 31744, v15
    v_xor_b32 v34, 2, v41
    v_lshlrev_b32 v34, 4, v34
    v_lshl_add_u32 v12, v40, 10, v34
    v_add_u32 v12, s94, v12
    v_add_u32 v12, 6144, v12
    v_lshl_add_u32 v16, v40, 13, v34
    v_add_u32 v16, s95, v16
    v_add_u32 v16, 63488, v16
    v_xor_b32 v35, 3, v41
    v_lshlrev_b32 v35, 4, v35
    v_lshl_add_u32 v13, v40, 10, v35
    v_add_u32 v13, s94, v13
    v_add_u32 v13, 9216, v13
    v_lshl_add_u32 v17, v40, 13, v35
    v_add_u32 v17, s95, v17
    v_add_u32 v17, 95232, v17
    s_lshl_b32 s87, s101, 19
    s_add_u32 s94, s98, 65536
    s_mov_b32 s95, 0
    s_mov_b32 m0, s94
    s_nop 0
    buffer_load_dwordx4 v10, s[32:35], s95 offen offset:0 lds
    buffer_load_dwordx4 v11, s[32:35], s95 offen offset:1024 lds
    buffer_load_dwordx4 v12, s[32:35], s95 offen offset:2048 lds
    buffer_load_dwordx4 v13, s[32:35], s95 offen offset:3072 lds
    s_add_u32 s94, s98, 16384
    s_mov_b32 m0, s94
    s_nop 0
    buffer_load_dwordx4 v14, s[36:39], s87 offen offset:0 lds
    buffer_load_dwordx4 v15, s[36:39], s87 offen offset:1024 lds
    buffer_load_dwordx4 v16, s[36:39], s87 offen offset:2048 lds
    buffer_load_dwordx4 v17, s[36:39], s87 offen offset:3072 lds
    s_add_u32 s94, s98, 0
    s_mov_b32 s95, 256
    s_mov_b32 m0, s94
    s_nop 0
    buffer_load_dwordx4 v10, s[32:35], s95 offen offset:0 lds
    buffer_load_dwordx4 v11, s[32:35], s95 offen offset:1024 lds
    buffer_load_dwordx4 v12, s[32:35], s95 offen offset:2048 lds
    buffer_load_dwordx4 v13, s[32:35], s95 offen offset:3072 lds
    s_add_u32 s96, s87, 1048576
    s_add_u32 s94, s98, 49152
    s_mov_b32 m0, s94
    s_nop 0
    buffer_load_dwordx4 v14, s[36:39], s96 offen offset:0 lds
    buffer_load_dwordx4 v15, s[36:39], s96 offen offset:1024 lds
    buffer_load_dwordx4 v16, s[36:39], s96 offen offset:2048 lds
    buffer_load_dwordx4 v17, s[36:39], s96 offen offset:3072 lds
    s_add_u32 s64, s28, 25165824
    s_addc_u32 s65, s29, 0
    s_mov_b32 s66, 0x80040
    s_mov_b32 s67, 0x00020000
    s_mov_b32 s76, s26
    s_mov_b32 s77, s27
    s_mov_b32 s78, 0x100
    s_mov_b32 s79, 0x00020000
    v_lshlrev_b32 v19, 7, v1
    s_getpc_b64 s[14:15]
L_pc0:
    s_sub_u32 s14, s14, L_pc0-L_code_begin
    s_subb_u32 s15, s15, 0
    s_lshl_b32 s94, s84, 13
    v_add_u32 v42, s94, v19
    v_min_u32 v42, L_code_end-L_code_begin-4, v42
    global_load_dword v20, v42, s[14:15]
    s_lshl_b32 s94, s100, 2
    s_add_u32 s94, s94, s84
    s_mov_b32 s95, 0x1000000
    s_cmp_eq_u32 s94, 3
    s_cselect_b32 s95, 524288, s95
    v_mov_b32 v42, s95
    buffer_load_dwordx2 v[44:45], v42, s[64:67], 0 offen sc1
    s_lshl_b32 s94, s83, 3
    s_add_u32 s94, s94, s80
    s_lshl_b32 s95, s83, 5
    s_add_u32 s95, s95, s97
    s_cmp_eq_u32 s82, 1
    s_cselect_b32 s94, s95, s94
    s_lshl_b32 s94, s94, 18
    s_add_u32 s40, s6, s94
    s_addc_u32 s41, s7, 0
    s_mov_b32 s42, 0x40000
    s_mov_b32 s43, 0x00020000
    s_add_u32 s44, s8, s94
    s_addc_u32 s45, s9, 0
    s_mov_b32 s46, 0x40000
    s_mov_b32 s47, 0x00020000
    s_add_u32 s68, s8, s94
    s_addc_u32 s69, s9, 0
    s_mov_b32 s70, 0x40000
    s_mov_b32 s71, 0x00020000
    s_add_u32 s72, s6, s94
    s_addc_u32 s73, s7, 0
    s_mov_b32 s74, 0x40000
    s_mov_b32 s75, 0x00020000
    s_cmp_eq_u32 s86, 0
    s_cselect_b32 s60, s40, s44
    s_cselect_b32 s61, s41, s45
    s_cselect_b32 s62, s42, s46
    s_mov_b32 s63, 0x00020000
    s_cselect_b32 s88, 16384, 0
    s_add_u32 s88, s88, s23
    s_lshl_b32 s94, s81, 14
    s_cmp_eq_u32 s82, 1
    s_cselect_b32 s94, 0, s94
    s_add_u32 s88, s88, s94
    s_mov_b32 s89, 65536
    s_cselect_b32 s89, 16384, s89
    v_lshl_add_u32 v2, v40, 8, v32
    v_add_u32 v2, s17, v2
    v_mov_b32 v6, v2
    v_lshl_add_u32 v3, v40, 8, v33
    v_add_u32 v3, s17, v3
    v_mov_b32 v7, v3
    v_lshl_add_u32 v4, v40, 8, v34
    v_add_u32 v4, s17, v4
    v_mov_b32 v8, v4
    v_lshl_add_u32 v5, v40, 8, v35
    v_add_u32 v5, s17, v5
    v_mov_b32 v9, v5
    v_and_b32 v32, 31, v1
    v_and_b32 v33, 3, v32
    v_lshlrev_b32 v33, 2, v33
    v_bfe_u32 v34, v32, 2, 2
    v_or_b32 v33, v33, v34
    v_lshrrev_b32 v34, 5, v1
    v_xor_b32 v33, v33, v34
    v_lshlrev_b32 v33, 4, v33
    v_lshl_add_u32 v33, v32, 8, v33
    v_add_u32 v33, s16, v33
    v_add_u32 v22, s23, v33
    s_lshl_b32 s94, s86, 7
    v_xor_b32 v18, s94, v22
    s_lshl_b32 s94, s86, 13
    v_add_u32 v23, s94, v33
    v_and_b32 v32, 15, v1
    v_lshrrev_b32 v33, 1, v40
    v_and_b32 v34, 1, v40
    v_bfe_u32 v35, v32, 1, 1
    v_lshl_add_u32 v35, v34, 1, v35
    v_lshrrev_b32 v36, 2, v32
    v_lshlrev_b32 v37, 2, v36
    v_xor_b32 v35, v35, v37
    v_and_b32 v32, 1, v32
    v_lshlrev_b32 v32, 3, v32
    v_xor_b32 v38, v35, v33
    v_lshl_add_u32 v38, v38, 4, v32
    v_lshl_add_u32 v37, v33, 2, v36
    v_lshl_add_u32 v38, v37, 8, v38
    s_lshl_b32 s94, s86, 13
    s_lshl_b32 s95, s86, 7
    v_add_u32 v24, s94, v38
    v_add_u32 v24, s16, v24
    v_xor_b32 v24, s95, v24
    v_lshlrev_b32 v38, 1, v33
    v_xor_b32 v38, v35, v38
    v_lshl_add_u32 v38, v38, 4, v32
    v_lshl_add_u32 v37, v33, 3, v36
    v_lshl_add_u32 v38, v37, 8, v38
    v_xor_b32 v25, s95, v38
    v_add_u32 v46, s98, v27
    s_lshl_b32 s94, s80, 19
    s_lshl_b32 s95, s81, 8
    s_add_u32 s94, s94, s95
    s_add_u32 s48, s12, s94
    s_addc_u32 s49, s13, 0
    s_mov_b32 s50, 0x7fd00
    s_mov_b32 s51, 0x00020000
    s_and_b32 s94, s100, 0x1e7
    s_lshl_b32 s94, s94, 14
    s_add_u32 s94, s94, 0
    s_add_u32 s52, s28, s94
    s_addc_u32 s53, s29, 0
    s_mov_b32 s54, 0x64000
    s_mov_b32 s55, 0x00020000
    s_and_b32 s94, s100, 0x1f8
    s_lshl_b32 s94, s94, 14
    s_add_u32 s94, s94, 8388608
    s_add_u32 s56, s28, s94
    s_addc_u32 s57, s29, 0
    s_mov_b32 s58, 0x20000
    s_mov_b32 s59, 0x00020000
    s_mov_b32 s92, 0x3e0293ee
    s_mov_b32 s93, 0x41000000
    s_mov_b32 s99, 0
    v_add_u32 v47, 0x10000, v46
    v_mov_b32 v64, 0
    v_mov_b32 v65, 0
    v_mov_b32 v66, 0
    v_mov_b32 v67, 0
    v_mov_b32 v68, 0
    v_mov_b32 v69, 0
    v_mov_b32 v70, 0
    v_mov_b32 v71, 0
    v_mov_b32 v72, 0
    v_mov_b32 v73, 0
    v_mov_b32 v74, 0
    v_mov_b32 v75, 0
    v_mov_b32 v76, 0
    v_mov_b32 v77, 0
    v_mov_b32 v78, 0
    v_mov_b32 v79, 0
    v_mov_b32 v80, 0
    v_mov_b32 v81, 0
    v_mov_b32 v82, 0
    v_mov_b32 v83, 0
    v_mov_b32 v84, 0
    v_mov_b32 v85, 0
    v_mov_b32 v86, 0
    v_mov_b32 v87, 0
    v_mov_b32 v88, 0
    v_mov_b32 v89, 0
    v_mov_b32 v90, 0
    v_mov_b32 v91, 0
    v_mov_b32 v92, 0
    v_mov_b32 v93, 0
    v_mov_b32 v94, 0
    v_mov_b32 v95, 0
    v_mov_b32 v96, 0
    v_mov_b32 v97, 0
    v_mov_b32 v98, 0
    v_mov_b32 v99, 0
    v_mov_b32 v100, 0
    v_mov_b32 v101, 0
    v_mov_b32 v102, 0
    v_mov_b32 v103, 0
    v_mov_b32 v104, 0
    v_mov_b32 v105, 0
    v_mov_b32 v106, 0
    v_mov_b32 v107, 0
    v_mov_b32 v108, 0
    v_mov_b32 v109, 0
    v_mov_b32 v110, 0
    v_mov_b32 v111, 0
    v_mov_b32 v112, 0
    v_mov_b32 v113, 0
    v_mov_b32 v114, 0
    v_mov_b32 v115, 0
    v_mov_b32 v116, 0
    v_mov_b32 v117, 0
    v_mov_b32 v118, 0
    v_mov_b32 v119, 0
    v_mov_b32 v120, 0
    v_mov_b32 v121, 0
    v_mov_b32 v122, 0
    v_mov_b32 v123, 0
    v_mov_b32 v124, 0
    v_mov_b32 v125, 0
    v_mov_b32 v126, 0
    v_mov_b32 v127, 0
    s_mul_i32 s94, s86, 81920
    s_add_u32 s8, s94, 16384
    s_add_u32 s9, s94, 49152
    s_add_u32 s10, s94, 65536
    s_add_u32 s11, s94, 49152
    s_mov_b32 s90, 512
    s_add_u32 s91, s87, 2097152
    s_mov_b32 s88, 768
    s_add_u32 s89, s87, 3145728
    s_add_u32 m0, s98, 32768
    s_waitcnt vmcnt(10) lgkmcnt(0)
    s_barrier
    v_add_u32 v32, 65536, v18
    v_xor_b32 v33, 32, v32
    v_xor_b32 v34, 64, v32
    v_xor_b32 v35, 96, v32
    ds_read_b128 v[128:131], v32
    ds_read_b128 v[132:135], v33
    ds_read_b128 v[136:139], v34
    ds_read_b128 v[140:143], v35
    s_call_b64 s[30:31], L_wQ0
    s_waitcnt vmcnt(16) lgkmcnt(0)
    s_barrier
    v_add_u32 v32, 0, v18
    v_xor_b32 v33, 32, v32
    v_xor_b32 v34, 64, v32
    v_xor_b32 v35, 96, v32
    ds_read_b128 v[144:147], v32
    ds_read_b128 v[148:151], v33
    ds_read_b128 v[152:155], v34
    ds_read_b128 v[156:159], v35
    s_call_b64 s[30:31], L_wS1
    s_waitcnt vmcnt(4)
    ds_write_b128 v47, v[48:51] offset:0
    ds_write_b128 v47, v[52:55] offset:1024
    ds_write_b128 v47, v[56:59] offset:2048
    ds_write_b128 v47, v[60:63] offset:3072
    ds_write_b128 v46, v[224:227] offset:16384
    ds_write_b128 v46, v[228:231] offset:17408
    ds_write_b128 v46, v[232:235] offset:18432
    ds_write_b128 v46, v[236:239] offset:19456
    s_waitcnt lgkmcnt(0)
    s_barrier
    v_add_u32 v32, 32768, v18
    v_xor_b32 v33, 32, v32
    v_xor_b32 v34, 64, v32
    v_xor_b32 v35, 96, v32
    ds_read_b128 v[160:163], v32
    ds_read_b128 v[164:167], v33
    ds_read_b128 v[168:171], v34
    ds_read_b128 v[172:175], v35
    s_add_u32 s97, s3, 0
    s_and_b32 s97, s97, 0x3ffff
    s_add_u32 s94, s98, 0
    s_mov_b32 m0, s94
    s_nop 0
    buffer_load_dwordx4 v2, s[40:43], s97 offen offset:0 nt lds
    buffer_load_dwordx4 v3, s[40:43], s97 offen offset:1024 nt lds
    buffer_load_dwordx4 v4, s[40:43], s97 offen offset:2048 nt lds
    buffer_load_dwordx4 v5, s[40:43], s97 offen offset:3072 nt lds
    s_call_b64 s[30:31], L_wS2
    s_waitcnt vmcnt(4)
    ds_write_b128 v46, v[240:243] offset:49152
    ds_write_b128 v46, v[244:247] offset:50176
    ds_write_b128 v46, v[248:251] offset:51200
    ds_write_b128 v46, v[252:255] offset:52224
    s_waitcnt lgkmcnt(0)
    s_barrier
    v_add_u32 v32, 16384, v18
    v_xor_b32 v33, 32, v32
    v_xor_b32 v34, 64, v32
    v_xor_b32 v35, 96, v32
    ds_read_b128 v[176:179], v32
    ds_read_b128 v[180:183], v33
    ds_read_b128 v[184:187], v34
    ds_read_b128 v[188:191], v35
    s_add_u32 s97, s3, 16384
    s_and_b32 s97, s97, 0x3ffff
    s_add_u32 s94, s98, 32768
    s_mov_b32 m0, s94
    s_nop 0
    buffer_load_dwordx4 v2, s[40:43], s97 offen offset:0 nt lds
    buffer_load_dwordx4 v3, s[40:43], s97 offen offset:1024 nt lds
    buffer_load_dwordx4 v4, s[40:43], s97 offen offset:2048 nt lds
    buffer_load_dwordx4 v5, s[40:43], s97 offen offset:3072 nt lds
    s_lshl_b32 s94, s100, 2
    s_add_u32 s94, s94, s84
    s_cmp_lg_u32 s94, 3
    s_cbranch_scc1 L_noep_1
    v_add_u32 v44, 1, v44
    v_max_u32 v44, 1, v44
    v_mov_b32 v42, 524288
    v_mov_b32 v43, 0
    s_mov_b64 exec, 1
    buffer_store_dwordx2 v[44:45], v42, s[64:67], 0 offen sc1
    buffer_store_dwordx2 v[44:45], v43, s[76:79], 0 offen sc1
    s_mov_b64 exec, -1
    s_waitcnt vmcnt(0)
L_noep_1:
    s_call_b64 s[30:31], L_wS3
    s_waitcnt lgkmcnt(0)
    s_barrier
    s_xor_b32 s95, s98, 8192
    s_add_u32 s94, s98, 65536
    v_add_u32 v46, s94, v27
    s_add_u32 s94, s98, 16384
    v_add_u32 v47, s94, v27
    s_add_u32 s94, s95, 65536
    v_add_u32 v21, s94, v27
    s_add_u32 s94, s95, 16384
    v_add_u32 v26, s94, v27
    s_add_u32 s97, s3, 0
    s_and_b32 s97, s97, 0x3ffff
    s_add_u32 s94, s98, 49152
    s_mov_b32 m0, s94
    s_nop 0
    buffer_load_dwordx4 v6, s[44:47], s97 offen offset:0 nt lds
    buffer_load_dwordx4 v7, s[44:47], s97 offen offset:1024 nt lds
    buffer_load_dwordx4 v8, s[44:47], s97 offen offset:2048 nt lds
    buffer_load_dwordx4 v9, s[44:47], s97 offen offset:3072 nt lds
    s_call_b64 s[30:31], L_exch
    s_waitcnt lgkmcnt(0)
    s_barrier
    s_add_u32 s97, s3, 32768
    s_and_b32 s97, s97, 0x3ffff
    s_add_u32 s94, s98, 65536
    s_mov_b32 m0, s94
    s_nop 0
    buffer_load_dwordx4 v2, s[40:43], s97 offen offset:0 nt lds
    buffer_load_dwordx4 v3, s[40:43], s97 offen offset:1024 nt lds
    buffer_load_dwordx4 v4, s[40:43], s97 offen offset:2048 nt lds
    buffer_load_dwordx4 v5, s[40:43], s97 offen offset:3072 nt lds
    v_lshrrev_b32 v40, 5, v1
    v_lshlrev_b32 v41, 4, v40
    v_xor_b32 v41, v41, v22
    v_lshl_add_u32 v41, v40, 3, v41
    v_add_u32 v41, 16384, v41
    s_lshl_b32 s94, s86, 7
    v_xor_b32 v41, s94, v41
    v_mul_f32 v64, s92, v64
    v_mul_f32 v65, s92, v65
    v_mul_f32 v66, s92, v66
    v_mul_f32 v67, s92, v67
    v_cvt_pk_bf16_f32 v200, v64, v65
    v_cvt_pk_bf16_f32 v201, v66, v67
    v_xor_b32 v32, 0, v41
    ds_write_b64 v32, v[200:201]
    v_mul_f32 v68, s92, v68
    v_mul_f32 v69, s92, v69
    v_mul_f32 v70, s92, v70
    v_mul_f32 v71, s92, v71
    v_cvt_pk_bf16_f32 v202, v68, v69
    v_cvt_pk_bf16_f32 v203, v70, v71
    v_xor_b32 v33, 16, v41
    ds_write_b64 v33, v[202:203]
    v_mul_f32 v72, s92, v72
    v_mul_f32 v73, s92, v73
    v_mul_f32 v74, s92, v74
    v_mul_f32 v75, s92, v75
    v_cvt_pk_bf16_f32 v204, v72, v73
    v_cvt_pk_bf16_f32 v205, v74, v75
    v_xor_b32 v34, 32, v41
    ds_write_b64 v34, v[204:205]
    v_mul_f32 v76, s92, v76
    v_mul_f32 v77, s92, v77
    v_mul_f32 v78, s92, v78
    v_mul_f32 v79, s92, v79
    v_cvt_pk_bf16_f32 v206, v76, v77
    v_cvt_pk_bf16_f32 v207, v78, v79
    v_xor_b32 v35, 48, v41
    ds_write_b64 v35, v[206:207]
    v_mul_f32 v80, s92, v80
    v_mul_f32 v81, s92, v81
    v_mul_f32 v82, s92, v82
    v_mul_f32 v83, s92, v83
    v_cvt_pk_bf16_f32 v208, v80, v81
    v_cvt_pk_bf16_f32 v209, v82, v83
    v_xor_b32 v36, 64, v41
    ds_write_b64 v36, v[208:209]
    v_mul_f32 v84, s92, v84
    v_mul_f32 v85, s92, v85
    v_mul_f32 v86, s92, v86
    v_mul_f32 v87, s92, v87
    v_cvt_pk_bf16_f32 v210, v84, v85
    v_cvt_pk_bf16_f32 v211, v86, v87
    v_xor_b32 v37, 80, v41
    ds_write_b64 v37, v[210:211]
    v_mul_f32 v88, s92, v88
    v_mul_f32 v89, s92, v89
    v_mul_f32 v90, s92, v90
    v_mul_f32 v91, s92, v91
    v_cvt_pk_bf16_f32 v212, v88, v89
    v_cvt_pk_bf16_f32 v213, v90, v91
    v_xor_b32 v38, 96, v41
    ds_write_b64 v38, v[212:213]
    v_mul_f32 v92, s92, v92
    v_mul_f32 v93, s92, v93
    v_mul_f32 v94, s92, v94
    v_mul_f32 v95, s92, v95
    v_cvt_pk_bf16_f32 v214, v92, v93
    v_cvt_pk_bf16_f32 v215, v94, v95
    v_xor_b32 v39, 112, v41
    ds_write_b64 v39, v[214:215]
    s_waitcnt vmcnt(12) lgkmcnt(0)
    s_barrier
    v_add_u32 v32, 16384, v22
    v_xor_b32 v33, 32, v32
    v_xor_b32 v34, 64, v32
    v_xor_b32 v35, 96, v32
    v_xor_b32 v36, 128, v32
    v_xor_b32 v37, 160, v32
    v_xor_b32 v38, 192, v32
    v_xor_b32 v39, 224, v32
    ds_read_b128 v[128:131], v32
    ds_read_b128 v[132:135], v33
    ds_read_b128 v[136:139], v34
    ds_read_b128 v[140:143], v35
    ds_read_b128 v[144:147], v36
    ds_read_b128 v[148:151], v37
    ds_read_b128 v[152:155], v38
    ds_read_b128 v[156:159], v39
    v_add_u32 v32, 0, v23
    v_xor_b32 v33, 32, v32
    v_xor_b32 v34, 64, v32
    v_xor_b32 v35, 96, v32
    v_xor_b32 v36, 128, v32
    v_xor_b32 v37, 160, v32
    v_xor_b32 v38, 192, v32
    v_xor_b32 v39, 224, v32
    ds_read_b128 v[200:203], v32 offset:0
    ds_read_b128 v[204:207], v33 offset:0
    ds_read_b128 v[208:211], v34 offset:0
    ds_read_b128 v[212:215], v35 offset:0
    ds_read_b128 v[216:219], v36 offset:0
    ds_read_b128 v[220:223], v37 offset:0
    ds_read_b128 v[224:227], v38 offset:0
    ds_read_b128 v[228:231], v39 offset:0
    v_add_u32 v248, 0, v24
    v_xor_b32 v249, 32, v248
    v_xor_b32 v250, 64, v248
    v_xor_b32 v251, 96, v248
    v_xor_b32 v252, 128, v248
    v_xor_b32 v253, 160, v248
    v_xor_b32 v254, 192, v248
    v_xor_b32 v255, 224, v248
    v_mov_b32 v64, 0
    v_mov_b32 v65, 0
    v_mov_b32 v66, 0
    v_mov_b32 v67, 0
    v_mov_b32 v68, 0
    v_mov_b32 v69, 0
    v_mov_b32 v70, 0
    v_mov_b32 v71, 0
    v_mov_b32 v72, 0
    v_mov_b32 v73, 0
    v_mov_b32 v74, 0
    v_mov_b32 v75, 0
    v_mov_b32 v76, 0
    v_mov_b32 v77, 0
    v_mov_b32 v78, 0
    v_mov_b32 v79, 0
    v_mov_b32 v80, 0
    v_mov_b32 v81, 0
    v_mov_b32 v82, 0
    v_mov_b32 v83, 0
    v_mov_b32 v84, 0
    v_mov_b32 v85, 0
    v_mov_b32 v86, 0
    v_mov_b32 v87, 0
    v_mov_b32 v88, 0
    v_mov_b32 v89, 0
    v_mov_b32 v90, 0
    v_mov_b32 v91, 0
    v_mov_b32 v92, 0
    v_mov_b32 v93, 0
    v_mov_b32 v94, 0
    v_mov_b32 v95, 0
    v_mov_b32 v96, 0
    s_waitcnt vmcnt(8) lgkmcnt(0)
    s_barrier
    s_add_u32 s97, s3, 16384
    s_and_b32 s97, s97, 0x3ffff
    s_add_u32 s94, s98, 0
    s_mov_b32 m0, s94
    s_nop 0
    buffer_load_dwordx4 v6, s[44:47], s97 offen offset:0 nt lds
    buffer_load_dwordx4 v7, s[44:47], s97 offen offset:1024 nt lds
    buffer_load_dwordx4 v8, s[44:47], s97 offen offset:2048 nt lds
    buffer_load_dwordx4 v9, s[44:47], s97 offen offset:3072 nt lds
    s_add_u32 s97, s3, 49152
    s_and_b32 s97, s97, 0x3ffff
    s_add_u32 s94, s98, 16384
    s_mov_b32 m0, s94
    s_nop 0
    buffer_load_dwordx4 v2, s[40:43], s97 offen offset:0 nt lds
    buffer_load_dwordx4 v3, s[40:43], s97 offen offset:1024 nt lds
    buffer_load_dwordx4 v4, s[40:43], s97 offen offset:2048 nt lds
    buffer_load_dwordx4 v5, s[40:43], s97 offen offset:3072 nt lds
    v_mfma_f32_32x32x16_bf16 v[160:175], v[200:203], v[128:131], 0
    v_mov_b32 v97, 0
    v_mov_b32 v98, 0
    v_mov_b32 v99, 0
    v_mov_b32 v100, 0
    ds_read_b128 v[200:203], v32 offset:32768
    v_mfma_f32_32x32x16_bf16 v[160:175], v[204:207], v[132:135], v[160:175]
    v_mov_b32 v101, 0
    v_mov_b32 v102, 0
    v_mov_b32 v103, 0
    v_mov_b32 v104, 0
    ds_read_b128 v[204:207], v33 offset:32768
    v_mfma_f32_32x32x16_bf16 v[160:175], v[208:211], v[136:139], v[160:175]
    v_mov_b32 v105, 0
    v_mov_b32 v106, 0
    v_mov_b32 v107, 0
    v_mov_b32 v108, 0
    ds_read_b128 v[208:211], v34 offset:32768
    v_mfma_f32_32x32x16_bf16 v[160:175], v[212:215], v[140:143], v[160:175]
    v_mov_b32 v109, 0
    v_mov_b32 v110, 0
    v_mov_b32 v111, 0
    v_mov_b32 v112, 0
    ds_read_b128 v[212:215], v35 offset:32768
    v_mfma_f32_32x32x16_bf16 v[160:175], v[216:219], v[144:147], v[160:175]
    v_mov_b32 v113, 0
    v_mov_b32 v114, 0
    v_mov_b32 v115, 0
    v_mov_b32 v116, 0
    ds_read_b128 v[216:219], v36 offset:32768
    v_mfma_f32_32x32x16_bf16 v[160:175], v[220:223], v[148:151], v[160:175]
    v_mov_b32 v117, 0
    v_mov_b32 v118, 0
    v_mov_b32 v119, 0
    v_mov_b32 v120, 0
    ds_read_b128 v[220:223], v37 offset:32768
    v_mfma_f32_32x32x16_bf16 v[160:175], v[224:227], v[152:155], v[160:175]
    v_mov_b32 v121, 0
    v_mov_b32 v122, 0
    v_mov_b32 v123, 0
    v_mov_b32 v124, 0
    ds_read_b128 v[224:227], v38 offset:32768
    v_mfma_f32_32x32x16_bf16 v[160:175], v[228:231], v[156:159], v[160:175]
    v_mov_b32 v125, 0
    v_mov_b32 v126, 0
    v_mov_b32 v127, 0
    v_mov_b32 v29, 0
    ds_read_b128 v[228:231], v39 offset:32768
    s_add_u32 s90, s3, 32768
    s_and_b32 s90, s90, 0x3ffff
    s_add_u32 s91, s3, 65536
    s_and_b32 s91, s91, 0x3ffff
    s_mov_b32 s89, 0
    s_nop 5
    v_max3_f32 v28, v160, v161, v162
    v_max3_f32 v41, v163, v164, v165
    v_max3_f32 v28, v28, v166, v167
    v_max3_f32 v41, v41, v168, v169
    v_max3_f32 v28, v28, v170, v171
    v_max3_f32 v41, v41, v172, v173
    v_max3_f32 v28, v28, v174, v175
    v_max_f32 v28, v28, v41
    v_mov_b32 v41, v28
    s_nop 1
    v_permlane32_swap_b32 v28, v41
    s_nop 1
    v_max_f32 v28, v28, v41
    v_sub_f32 v160, v160, v28
    v_sub_f32 v161, v161, v28
    v_sub_f32 v162, v162, v28
    v_sub_f32 v163, v163, v28
    v_sub_f32 v164, v164, v28
    v_sub_f32 v165, v165, v28
    v_sub_f32 v166, v166, v28
    v_sub_f32 v167, v167, v28
    v_sub_f32 v168, v168, v28
    v_sub_f32 v169, v169, v28
    v_sub_f32 v170, v170, v28
    v_sub_f32 v171, v171, v28
    v_sub_f32 v172, v172, v28
    v_sub_f32 v173, v173, v28
    v_sub_f32 v174, v174, v28
    v_sub_f32 v175, v175, v28
    v_sub_f32 v232, 0, v28
    v_sub_f32 v233, 0, v28
    v_sub_f32 v234, 0, v28
    v_sub_f32 v235, 0, v28
    v_sub_f32 v236, 0, v28
    v_sub_f32 v237, 0, v28
    v_sub_f32 v238, 0, v28
    v_sub_f32 v239, 0, v28
    v_sub_f32 v240, 0, v28
    v_sub_f32 v241, 0, v28
    v_sub_f32 v242, 0, v28
    v_sub_f32 v243, 0, v28
    v_sub_f32 v244, 0, v28
    v_sub_f32 v245, 0, v28
    v_sub_f32 v246, 0, v28
    v_sub_f32 v247, 0, v28
    v_exp_f32 v176, v160
    v_exp_f32 v177, v161
    v_exp_f32 v178, v162
    v_exp_f32 v179, v163
    v_exp_f32 v180, v164
    v_exp_f32 v181, v165
    v_exp_f32 v182, v166
    v_exp_f32 v183, v167
    v_exp_f32 v184, v168
    v_exp_f32 v185, v169
    v_exp_f32 v186, v170
    v_exp_f32 v187, v171
    v_exp_f32 v188, v172
    v_exp_f32 v189, v173
    v_exp_f32 v190, v174
    v_exp_f32 v191, v175
    s_waitcnt vmcnt(12) lgkmcnt(0)
    s_barrier
.p2align 8
L_loop:
    s_add_u32 m0, s98, 32768
    v_mfma_f32_32x32x16_bf16 v[160:175], v[200:203], v[128:131], v[232:247]
    v_add_f32 v40, v176, v177
    v_add_f32 v41, v178, v179
    v_add_f32 v40, v40, v180
    ds_read_b64_tr_b16 v[200:201], v248 offset:49152
    ds_read_b64_tr_b16 v[202:203], v249 offset:51200
    v_mfma_f32_32x32x16_bf16 v[160:175], v[204:207], v[132:135], v[160:175]
    v_add_f32 v41, v41, v181
    v_add_f32 v40, v40, v182
    v_add_f32 v41, v41, v183
    ds_read_b64_tr_b16 v[204:205], v250 offset:49152
    ds_read_b64_tr_b16 v[206:207], v251 offset:51200
    buffer_load_dwordx4 v2, s[68:71], s90 offen offset:0 nt lds
    v_mfma_f32_32x32x16_bf16 v[160:175], v[208:211], v[136:139], v[160:175]
    v_add_f32 v40, v40, v184
    v_add_f32 v41, v41, v185
    v_add_f32 v40, v40, v186
    ds_read_b64_tr_b16 v[208:209], v252 offset:49152
    ds_read_b64_tr_b16 v[210:211], v253 offset:51200
    v_mfma_f32_32x32x16_bf16 v[160:175], v[212:215], v[140:143], v[160:175]
    v_add_f32 v41, v41, v187
    v_add_f32 v40, v40, v188
    v_add_f32 v41, v41, v189
    ds_read_b64_tr_b16 v[212:213], v254 offset:49152
    ds_read_b64_tr_b16 v[214:215], v255 offset:51200
    buffer_load_dwordx4 v3, s[68:71], s90 offen offset:1024 nt lds
    v_mfma_f32_32x32x16_bf16 v[160:175], v[216:219], v[144:147], v[160:175]
    v_add_f32 v40, v40, v190
    v_add_f32 v41, v41, v191
    v_cvt_pk_bf16_f32 v192, v176, v177
    ds_read_b64_tr_b16 v[216:217], v248 offset:53248
    ds_read_b64_tr_b16 v[218:219], v249 offset:55296
    buffer_load_dwordx4 v4, s[68:71], s90 offen offset:2048 nt lds
    v_mfma_f32_32x32x16_bf16 v[160:175], v[220:223], v[148:151], v[160:175]
    v_cvt_pk_bf16_f32 v193, v178, v179
    v_cvt_pk_bf16_f32 v194, v180, v181
    v_cvt_pk_bf16_f32 v195, v182, v183
    ds_read_b64_tr_b16 v[220:221], v250 offset:53248
    ds_read_b64_tr_b16 v[222:223], v251 offset:55296
    v_mfma_f32_32x32x16_bf16 v[160:175], v[224:227], v[152:155], v[160:175]
    v_cvt_pk_bf16_f32 v196, v184, v185
    v_cvt_pk_bf16_f32 v197, v186, v187
    v_cvt_pk_bf16_f32 v198, v188, v189
    ds_read_b64_tr_b16 v[224:225], v252 offset:53248
    ds_read_b64_tr_b16 v[226:227], v253 offset:55296
    buffer_load_dwordx4 v5, s[68:71], s90 offen offset:3072 nt lds
    v_mfma_f32_32x32x16_bf16 v[160:175], v[228:231], v[156:159], v[160:175]
    v_cvt_pk_bf16_f32 v199, v190, v191
    v_add_f32 v40, v40, v41
    v_add_f32 v29, v29, v40
    ds_read_b64_tr_b16 v[228:229], v254 offset:53248
    ds_read_b64_tr_b16 v[230:231], v255 offset:55296
    s_add_u32 s90, s90, 16384
    s_and_b32 s90, s90, 0x3ffff
    s_waitcnt vmcnt(12) lgkmcnt(0)
    s_barrier
    s_add_u32 m0, s98, 49152
    v_mfma_f32_32x32x16_bf16 v[64:79], v[200:203], v[192:195], v[64:79]
    v_add_u32 v43, 0x10000, v32
    ds_read_b128 v[200:203], v43 offset:0
    buffer_load_dwordx4 v6, s[72:75], s91 offen offset:0 nt lds
    v_max3_f32 v40, v160, v161, v162
    v_max3_f32 v41, v163, v164, v165
    v_max3_f32 v40, v40, v166, v167
    v_max3_f32 v41, v41, v168, v169
    v_mfma_f32_32x32x16_bf16 v[80:95], v[204:207], v[192:195], v[80:95]
    v_max3_f32 v40, v40, v170, v171
    v_max3_f32 v41, v41, v172, v173
    v_max3_f32 v40, v40, v174, v175
    v_max_f32 v40, v40, v41
    v_mov_b32 v41, v40
    v_add_u32 v43, 0x10000, v33
    ds_read_b128 v[204:207], v43 offset:0
    v_mfma_f32_32x32x16_bf16 v[96:111], v[208:211], v[192:195], v[96:111]
    v_add_u32 v43, 0x10000, v34
    ds_read_b128 v[208:211], v43 offset:0
    v_permlane32_swap_b32 v40, v41
    v_max_f32 v40, v40, v41
    v_cmp_lt_f32 vcc, s93, v40
    buffer_load_dwordx4 v7, s[72:75], s91 offen offset:1024 nt lds
    v_mfma_f32_32x32x16_bf16 v[112:127], v[212:215], v[192:195], v[112:127]
    v_add_u32 v43, 0x10000, v35
    ds_read_b128 v[212:215], v43 offset:0
    s_cbranch_vccz L_nr1_2
    v_max_f32 v40, 0, v40
    v_exp_f32 v30, -v40
    v_add_f32 v28, v28, v40
    v_sub_f32 v160, v160, v40
    v_sub_f32 v161, v161, v40
    v_sub_f32 v162, v162, v40
    v_sub_f32 v163, v163, v40
    v_sub_f32 v164, v164, v40
    v_sub_f32 v165, v165, v40
    v_sub_f32 v166, v166, v40
    v_sub_f32 v167, v167, v40
    v_sub_f32 v168, v168, v40
    v_sub_f32 v169, v169, v40
    v_sub_f32 v170, v170, v40
    v_sub_f32 v171, v171, v40
    v_sub_f32 v172, v172, v40
    v_sub_f32 v173, v173, v40
    v_sub_f32 v174, v174, v40
    v_sub_f32 v175, v175, v40
    v_sub_f32 v232, 0, v28
    v_sub_f32 v233, 0, v28
    v_sub_f32 v234, 0, v28
    v_sub_f32 v235, 0, v28
    v_sub_f32 v236, 0, v28
    v_sub_f32 v237, 0, v28
    v_sub_f32 v238, 0, v28
    v_sub_f32 v239, 0, v28
    v_sub_f32 v240, 0, v28
    v_sub_f32 v241, 0, v28
    v_sub_f32 v242, 0, v28
    v_sub_f32 v243, 0, v28
    v_sub_f32 v244, 0, v28
    v_sub_f32 v245, 0, v28
    v_sub_f32 v246, 0, v28
    v_sub_f32 v247, 0, v28
    s_mov_b32 s99, 1
L_nr1_2:
    v_exp_f32 v176, v160
    v_exp_f32 v177, v161
    v_exp_f32 v178, v162
    v_mfma_f32_32x32x16_bf16 v[64:79], v[216:219], v[196:199], v[64:79]
    v_exp_f32 v179, v163
    v_exp_f32 v180, v164
    v_exp_f32 v181, v165
    v_add_u32 v43, 0x10000, v36
    ds_read_b128 v[216:219], v43 offset:0
    buffer_load_dwordx4 v8, s[72:75], s91 offen offset:2048 nt lds
    v_mfma_f32_32x32x16_bf16 v[80:95], v[220:223], v[196:199], v[80:95]
    v_exp_f32 v182, v166
    v_exp_f32 v183, v167
    v_exp_f32 v184, v168
    v_add_u32 v43, 0x10000, v37
    ds_read_b128 v[220:223], v43 offset:0
    v_mfma_f32_32x32x16_bf16 v[96:111], v[224:227], v[196:199], v[96:111]
    v_exp_f32 v185, v169
    v_exp_f32 v186, v170
    v_exp_f32 v187, v171
    v_add_u32 v43, 0x10000, v38
    ds_read_b128 v[224:227], v43 offset:0
    buffer_load_dwordx4 v9, s[72:75], s91 offen offset:3072 nt lds
    v_mfma_f32_32x32x16_bf16 v[112:127], v[228:231], v[196:199], v[112:127]
    v_add_u32 v43, 0x10000, v39
    ds_read_b128 v[228:231], v43 offset:0
    v_exp_f32 v188, v172
    v_exp_f32 v189, v173
    v_exp_f32 v190, v174
    v_exp_f32 v191, v175
    s_cmp_eq_u32 s99, 0
    s_cbranch_scc1 L_nr2_3
    s_nop 15
    v_mul_f32 v29, v29, v30
    v_mul_f32 v64, v64, v30
    v_mul_f32 v65, v65, v30
    v_mul_f32 v66, v66, v30
    v_mul_f32 v67, v67, v30
    v_mul_f32 v68, v68, v30
    v_mul_f32 v69, v69, v30
    v_mul_f32 v70, v70, v30
    v_mul_f32 v71, v71, v30
    v_mul_f32 v72, v72, v30
    v_mul_f32 v73, v73, v30
    v_mul_f32 v74, v74, v30
    v_mul_f32 v75, v75, v30
    v_mul_f32 v76, v76, v30
    v_mul_f32 v77, v77, v30
    v_mul_f32 v78, v78, v30
    v_mul_f32 v79, v79, v30
    v_mul_f32 v80, v80, v30
    v_mul_f32 v81, v81, v30
    v_mul_f32 v82, v82, v30
    v_mul_f32 v83, v83, v30
    v_mul_f32 v84, v84, v30
    v_mul_f32 v85, v85, v30
    v_mul_f32 v86, v86, v30
    v_mul_f32 v87, v87, v30
    v_mul_f32 v88, v88, v30
    v_mul_f32 v89, v89, v30
    v_mul_f32 v90, v90, v30
    v_mul_f32 v91, v91, v30
    v_mul_f32 v92, v92, v30
    v_mul_f32 v93, v93, v30
    v_mul_f32 v94, v94, v30
    v_mul_f32 v95, v95, v30
    v_mul_f32 v96, v96, v30
    v_mul_f32 v97, v97, v30
    v_mul_f32 v98, v98, v30
    v_mul_f32 v99, v99, v30
    v_mul_f32 v100, v100, v30
    v_mul_f32 v101, v101, v30
    v_mul_f32 v102, v102, v30
    v_mul_f32 v103, v103, v30
    v_mul_f32 v104, v104, v30
    v_mul_f32 v105, v105, v30
    v_mul_f32 v106, v106, v30
    v_mul_f32 v107, v107, v30
    v_mul_f32 v108, v108, v30
    v_mul_f32 v109, v109, v30
    v_mul_f32 v110, v110, v30
    v_mul_f32 v111, v111, v30
    v_mul_f32 v112, v112, v30
    v_mul_f32 v113, v113, v30
    v_mul_f32 v114, v114, v30
    v_mul_f32 v115, v115, v30
    v_mul_f32 v116, v116, v30
    v_mul_f32 v117, v117, v30
    v_mul_f32 v118, v118, v30
    v_mul_f32 v119, v119, v30
    v_mul_f32 v120, v120, v30
    v_mul_f32 v121, v121, v30
    v_mul_f32 v122, v122, v30
    v_mul_f32 v123, v123, v30
    v_mul_f32 v124, v124, v30
    v_mul_f32 v125, v125, v30
    v_mul_f32 v126, v126, v30
    v_mul_f32 v127, v127, v30
    s_mov_b32 s99, 0
L_nr2_3:
    s_add_u32 s91, s91, 16384
    s_and_b32 s91, s91, 0x3ffff
    s_waitcnt vmcnt(12) lgkmcnt(0)
    s_barrier
    s_add_u32 m0, s98, 65536
    v_mfma_f32_32x32x16_bf16 v[160:175], v[200:203], v[128:131], v[232:247]
    v_add_f32 v40, v176, v177
    v_add_f32 v41, v178, v179
    v_add_f32 v40, v40, v180
    ds_read_b64_tr_b16 v[200:201], v248 offset:0
    ds_read_b64_tr_b16 v[202:203], v249 offset:2048
    v_mfma_f32_32x32x16_bf16 v[160:175], v[204:207], v[132:135], v[160:175]
    v_add_f32 v41, v41, v181
    v_add_f32 v40, v40, v182
    v_add_f32 v41, v41, v183
    ds_read_b64_tr_b16 v[204:205], v250 offset:0
    ds_read_b64_tr_b16 v[206:207], v251 offset:2048
    buffer_load_dwordx4 v2, s[68:71], s90 offen offset:0 nt lds
    v_mfma_f32_32x32x16_bf16 v[160:175], v[208:211], v[136:139], v[160:175]
    v_add_f32 v40, v40, v184
    v_add_f32 v41, v41, v185
    v_add_f32 v40, v40, v186
    ds_read_b64_tr_b16 v[208:209], v252 offset:0
    ds_read_b64_tr_b16 v[210:211], v253 offset:2048
    v_mfma_f32_32x32x16_bf16 v[160:175], v[212:215], v[140:143], v[160:175]
    v_add_f32 v41, v41, v187
    v_add_f32 v40, v40, v188
    v_add_f32 v41, v41, v189
    ds_read_b64_tr_b16 v[212:213], v254 offset:0
    ds_read_b64_tr_b16 v[214:215], v255 offset:2048
    buffer_load_dwordx4 v3, s[68:71], s90 offen offset:1024 nt lds
    v_mfma_f32_32x32x16_bf16 v[160:175], v[216:219], v[144:147], v[160:175]
    v_add_f32 v40, v40, v190
    v_add_f32 v41, v41, v191
    v_cvt_pk_bf16_f32 v192, v176, v177
    ds_read_b64_tr_b16 v[216:217], v248 offset:4096
    ds_read_b64_tr_b16 v[218:219], v249 offset:6144
    buffer_load_dwordx4 v4, s[68:71], s90 offen offset:2048 nt lds
    v_mfma_f32_32x32x16_bf16 v[160:175], v[220:223], v[148:151], v[160:175]
    v_cvt_pk_bf16_f32 v193, v178, v179
    v_cvt_pk_bf16_f32 v194, v180, v181
    v_cvt_pk_bf16_f32 v195, v182, v183
    ds_read_b64_tr_b16 v[220:221], v250 offset:4096
    ds_read_b64_tr_b16 v[222:223], v251 offset:6144
    v_mfma_f32_32x32x16_bf16 v[160:175], v[224:227], v[152:155], v[160:175]
    v_cvt_pk_bf16_f32 v196, v184, v185
    v_cvt_pk_bf16_f32 v197, v186, v187
    v_cvt_pk_bf16_f32 v198, v188, v189
    ds_read_b64_tr_b16 v[224:225], v252 offset:4096
    ds_read_b64_tr_b16 v[226:227], v253 offset:6144
    buffer_load_dwordx4 v5, s[68:71], s90 offen offset:3072 nt lds
    v_mfma_f32_32x32x16_bf16 v[160:175], v[228:231], v[156:159], v[160:175]
    v_cvt_pk_bf16_f32 v199, v190, v191
    v_add_f32 v40, v40, v41
    v_add_f32 v29, v29, v40
    ds_read_b64_tr_b16 v[228:229], v254 offset:4096
    ds_read_b64_tr_b16 v[230:231], v255 offset:6144
    s_add_u32 s90, s90, 16384
    s_and_b32 s90, s90, 0x3ffff
    s_waitcnt vmcnt(12) lgkmcnt(0)
    s_barrier
    s_add_u32 m0, s98, 0
    v_mfma_f32_32x32x16_bf16 v[64:79], v[200:203], v[192:195], v[64:79]
    ds_read_b128 v[200:203], v32 offset:16384
    buffer_load_dwordx4 v6, s[72:75], s91 offen offset:0 nt lds
    v_max3_f32 v40, v160, v161, v162
    v_max3_f32 v41, v163, v164, v165
    v_max3_f32 v40, v40, v166, v167
    v_max3_f32 v41, v41, v168, v169
    v_mfma_f32_32x32x16_bf16 v[80:95], v[204:207], v[192:195], v[80:95]
    v_max3_f32 v40, v40, v170, v171
    v_max3_f32 v41, v41, v172, v173
    v_max3_f32 v40, v40, v174, v175
    v_max_f32 v40, v40, v41
    v_mov_b32 v41, v40
    ds_read_b128 v[204:207], v33 offset:16384
    v_mfma_f32_32x32x16_bf16 v[96:111], v[208:211], v[192:195], v[96:111]
    ds_read_b128 v[208:211], v34 offset:16384
    v_permlane32_swap_b32 v40, v41
    v_max_f32 v40, v40, v41
    v_cmp_lt_f32 vcc, s93, v40
    buffer_load_dwordx4 v7, s[72:75], s91 offen offset:1024 nt lds
    v_mfma_f32_32x32x16_bf16 v[112:127], v[212:215], v[192:195], v[112:127]
    ds_read_b128 v[212:215], v35 offset:16384
    s_cbranch_vccz L_nr1_4
    v_max_f32 v40, 0, v40
    v_exp_f32 v30, -v40
    v_add_f32 v28, v28, v40
    v_sub_f32 v160, v160, v40
    v_sub_f32 v161, v161, v40
    v_sub_f32 v162, v162, v40
    v_sub_f32 v163, v163, v40
    v_sub_f32 v164, v164, v40
    v_sub_f32 v165, v165, v40
    v_sub_f32 v166, v166, v40
    v_sub_f32 v167, v167, v40
    v_sub_f32 v168, v168, v40
    v_sub_f32 v169, v169, v40
    v_sub_f32 v170, v170, v40
    v_sub_f32 v171, v171, v40
    v_sub_f32 v172, v172, v40
    v_sub_f32 v173, v173, v40
    v_sub_f32 v174, v174, v40
    v_sub_f32 v175, v175, v40
    v_sub_f32 v232, 0, v28
    v_sub_f32 v233, 0, v28
    v_sub_f32 v234, 0, v28
    v_sub_f32 v235, 0, v28
    v_sub_f32 v236, 0, v28
    v_sub_f32 v237, 0, v28
    v_sub_f32 v238, 0, v28
    v_sub_f32 v239, 0, v28
    v_sub_f32 v240, 0, v28
    v_sub_f32 v241, 0, v28
    v_sub_f32 v242, 0, v28
    v_sub_f32 v243, 0, v28
    v_sub_f32 v244, 0, v28
    v_sub_f32 v245, 0, v28
    v_sub_f32 v246, 0, v28
    v_sub_f32 v247, 0, v28
    s_mov_b32 s99, 1
L_nr1_4:
    v_exp_f32 v176, v160
    v_exp_f32 v177, v161
    v_exp_f32 v178, v162
    v_mfma_f32_32x32x16_bf16 v[64:79], v[216:219], v[196:199], v[64:79]
    v_exp_f32 v179, v163
    v_exp_f32 v180, v164
    v_exp_f32 v181, v165
    ds_read_b128 v[216:219], v36 offset:16384
    buffer_load_dwordx4 v8, s[72:75], s91 offen offset:2048 nt lds
    v_mfma_f32_32x32x16_bf16 v[80:95], v[220:223], v[196:199], v[80:95]
    v_exp_f32 v182, v166
    v_exp_f32 v183, v167
    v_exp_f32 v184, v168
    ds_read_b128 v[220:223], v37 offset:16384
    v_mfma_f32_32x32x16_bf16 v[96:111], v[224:227], v[196:199], v[96:111]
    v_exp_f32 v185, v169
    v_exp_f32 v186, v170
    v_exp_f32 v187, v171
    ds_read_b128 v[224:227], v38 offset:16384
    buffer_load_dwordx4 v9, s[72:75], s91 offen offset:3072 nt lds
    v_mfma_f32_32x32x16_bf16 v[112:127], v[228:231], v[196:199], v[112:127]
    ds_read_b128 v[228:231], v39 offset:16384
    v_exp_f32 v188, v172
    v_exp_f32 v189, v173
    v_exp_f32 v190, v174
    v_exp_f32 v191, v175
    s_cmp_eq_u32 s99, 0
    s_cbranch_scc1 L_nr2_5
    s_nop 15
    v_mul_f32 v29, v29, v30
    v_mul_f32 v64, v64, v30
    v_mul_f32 v65, v65, v30
    v_mul_f32 v66, v66, v30
    v_mul_f32 v67, v67, v30
    v_mul_f32 v68, v68, v30
    v_mul_f32 v69, v69, v30
    v_mul_f32 v70, v70, v30
    v_mul_f32 v71, v71, v30
    v_mul_f32 v72, v72, v30
    v_mul_f32 v73, v73, v30
    v_mul_f32 v74, v74, v30
    v_mul_f32 v75, v75, v30
    v_mul_f32 v76, v76, v30
    v_mul_f32 v77, v77, v30
    v_mul_f32 v78, v78, v30
    v_mul_f32 v79, v79, v30
    v_mul_f32 v80, v80, v30
    v_mul_f32 v81, v81, v30
    v_mul_f32 v82, v82, v30
    v_mul_f32 v83, v83, v30
    v_mul_f32 v84, v84, v30
    v_mul_f32 v85, v85, v30
    v_mul_f32 v86, v86, v30
    v_mul_f32 v87, v87, v30
    v_mul_f32 v88, v88, v30
    v_mul_f32 v89, v89, v30
    v_mul_f32 v90, v90, v30
    v_mul_f32 v91, v91, v30
    v_mul_f32 v92, v92, v30
    v_mul_f32 v93, v93, v30
    v_mul_f32 v94, v94, v30
    v_mul_f32 v95, v95, v30
    v_mul_f32 v96, v96, v30
    v_mul_f32 v97, v97, v30
    v_mul_f32 v98, v98, v30
    v_mul_f32 v99, v99, v30
    v_mul_f32 v100, v100, v30
    v_mul_f32 v101, v101, v30
    v_mul_f32 v102, v102, v30
    v_mul_f32 v103, v103, v30
    v_mul_f32 v104, v104, v30
    v_mul_f32 v105, v105, v30
    v_mul_f32 v106, v106, v30
    v_mul_f32 v107, v107, v30
    v_mul_f32 v108, v108, v30
    v_mul_f32 v109, v109, v30
    v_mul_f32 v110, v110, v30
    v_mul_f32 v111, v111, v30
    v_mul_f32 v112, v112, v30
    v_mul_f32 v113, v113, v30
    v_mul_f32 v114, v114, v30
    v_mul_f32 v115, v115, v30
    v_mul_f32 v116, v116, v30
    v_mul_f32 v117, v117, v30
    v_mul_f32 v118, v118, v30
    v_mul_f32 v119, v119, v30
    v_mul_f32 v120, v120, v30
    v_mul_f32 v121, v121, v30
    v_mul_f32 v122, v122, v30
    v_mul_f32 v123, v123, v30
    v_mul_f32 v124, v124, v30
    v_mul_f32 v125, v125, v30
    v_mul_f32 v126, v126, v30
    v_mul_f32 v127, v127, v30
    s_mov_b32 s99, 0
L_nr2_5:
    s_add_u32 s91, s91, 16384
    s_and_b32 s91, s91, 0x3ffff
    s_cmp_eq_u32 s89, 2
    s_cbranch_scc1 L_v11
L_vback1:
    s_waitcnt vmcnt(12) lgkmcnt(0)
    s_barrier
    s_add_u32 m0, s98, 16384
    v_mfma_f32_32x32x16_bf16 v[160:175], v[200:203], v[128:131], v[232:247]
    v_add_f32 v40, v176, v177
    v_add_f32 v41, v178, v179
    v_add_f32 v40, v40, v180
    ds_read_b64_tr_b16 v[200:201], v248 offset:32768
    ds_read_b64_tr_b16 v[202:203], v249 offset:34816
    v_mfma_f32_32x32x16_bf16 v[160:175], v[204:207], v[132:135], v[160:175]
    v_add_f32 v41, v41, v181
    v_add_f32 v40, v40, v182
    v_add_f32 v41, v41, v183
    ds_read_b64_tr_b16 v[204:205], v250 offset:32768
    ds_read_b64_tr_b16 v[206:207], v251 offset:34816
    buffer_load_dwordx4 v2, s[68:71], s90 offen offset:0 nt lds
    v_mfma_f32_32x32x16_bf16 v[160:175], v[208:211], v[136:139], v[160:175]
    v_add_f32 v40, v40, v184
    v_add_f32 v41, v41, v185
    v_add_f32 v40, v40, v186
    ds_read_b64_tr_b16 v[208:209], v252 offset:32768
    ds_read_b64_tr_b16 v[210:211], v253 offset:34816
    v_mfma_f32_32x32x16_bf16 v[160:175], v[212:215], v[140:143], v[160:175]
    v_add_f32 v41, v41, v187
    v_add_f32 v40, v40, v188
    v_add_f32 v41, v41, v189
    ds_read_b64_tr_b16 v[212:213], v254 offset:32768
    ds_read_b64_tr_b16 v[214:215], v255 offset:34816
    buffer_load_dwordx4 v3, s[68:71], s90 offen offset:1024 nt lds
    v_mfma_f32_32x32x16_bf16 v[160:175], v[216:219], v[144:147], v[160:175]
    v_add_f32 v40, v40, v190
    v_add_f32 v41, v41, v191
    v_cvt_pk_bf16_f32 v192, v176, v177
    ds_read_b64_tr_b16 v[216:217], v248 offset:36864
    ds_read_b64_tr_b16 v[218:219], v249 offset:38912
    buffer_load_dwordx4 v4, s[68:71], s90 offen offset:2048 nt lds
    v_mfma_f32_32x32x16_bf16 v[160:175], v[220:223], v[148:151], v[160:175]
    v_cvt_pk_bf16_f32 v193, v178, v179
    v_cvt_pk_bf16_f32 v194, v180, v181
    v_cvt_pk_bf16_f32 v195, v182, v183
    ds_read_b64_tr_b16 v[220:221], v250 offset:36864
    ds_read_b64_tr_b16 v[222:223], v251 offset:38912
    v_mfma_f32_32x32x16_bf16 v[160:175], v[224:227], v[152:155], v[160:175]
    v_cvt_pk_bf16_f32 v196, v184, v185
    v_cvt_pk_bf16_f32 v197, v186, v187
    v_cvt_pk_bf16_f32 v198, v188, v189
    ds_read_b64_tr_b16 v[224:225], v252 offset:36864
    ds_read_b64_tr_b16 v[226:227], v253 offset:38912
    buffer_load_dwordx4 v5, s[68:71], s90 offen offset:3072 nt lds
    v_mfma_f32_32x32x16_bf16 v[160:175], v[228:231], v[156:159], v[160:175]
    v_cvt_pk_bf16_f32 v199, v190, v191
    v_add_f32 v40, v40, v41
    v_add_f32 v29, v29, v40
    ds_read_b64_tr_b16 v[228:229], v254 offset:36864
    ds_read_b64_tr_b16 v[230:231], v255 offset:38912
    s_add_u32 s90, s90, 16384
    s_and_b32 s90, s90, 0x3ffff
    s_cmp_eq_u32 s89, 2
    s_cbranch_scc1 L_k12
L_kback2:
    s_waitcnt vmcnt(12) lgkmcnt(0)
    s_barrier
    s_add_u32 m0, s98, 32768
    v_mfma_f32_32x32x16_bf16 v[64:79], v[200:203], v[192:195], v[64:79]
    ds_read_b128 v[200:203], v32 offset:49152
    buffer_load_dwordx4 v6, s[72:75], s91 offen offset:0 nt lds
    v_max3_f32 v40, v160, v161, v162
    v_max3_f32 v41, v163, v164, v165
    v_max3_f32 v40, v40, v166, v167
    v_max3_f32 v41, v41, v168, v169
    v_mfma_f32_32x32x16_bf16 v[80:95], v[204:207], v[192:195], v[80:95]
    v_max3_f32 v40, v40, v170, v171
    v_max3_f32 v41, v41, v172, v173
    v_max3_f32 v40, v40, v174, v175
    v_max_f32 v40, v40, v41
    v_mov_b32 v41, v40
    ds_read_b128 v[204:207], v33 offset:49152
    v_mfma_f32_32x32x16_bf16 v[96:111], v[208:211], v[192:195], v[96:111]
    ds_read_b128 v[208:211], v34 offset:49152
    v_permlane32_swap_b32 v40, v41
    v_max_f32 v40, v40, v41
    v_cmp_lt_f32 vcc, s93, v40
    buffer_load_dwordx4 v7, s[72:75], s91 offen offset:1024 nt lds
    v_mfma_f32_32x32x16_bf16 v[112:127], v[212:215], v[192:195], v[112:127]
    ds_read_b128 v[212:215], v35 offset:49152
    s_cbranch_vccz L_nr1_6
    v_max_f32 v40, 0, v40
    v_exp_f32 v30, -v40
    v_add_f32 v28, v28, v40
    v_sub_f32 v160, v160, v40
    v_sub_f32 v161, v161, v40
    v_sub_f32 v162, v162, v40
    v_sub_f32 v163, v163, v40
    v_sub_f32 v164, v164, v40
    v_sub_f32 v165, v165, v40
    v_sub_f32 v166, v166, v40
    v_sub_f32 v167, v167, v40
    v_sub_f32 v168, v168, v40
    v_sub_f32 v169, v169, v40
    v_sub_f32 v170, v170, v40
    v_sub_f32 v171, v171, v40
    v_sub_f32 v172, v172, v40
    v_sub_f32 v173, v173, v40
    v_sub_f32 v174, v174, v40
    v_sub_f32 v175, v175, v40
    v_sub_f32 v232, 0, v28
    v_sub_f32 v233, 0, v28
    v_sub_f32 v234, 0, v28
    v_sub_f32 v235, 0, v28
    v_sub_f32 v236, 0, v28
    v_sub_f32 v237, 0, v28
    v_sub_f32 v238, 0, v28
    v_sub_f32 v239, 0, v28
    v_sub_f32 v240, 0, v28
    v_sub_f32 v241, 0, v28
    v_sub_f32 v242, 0, v28
    v_sub_f32 v243, 0, v28
    v_sub_f32 v244, 0, v28
    v_sub_f32 v245, 0, v28
    v_sub_f32 v246, 0, v28
    v_sub_f32 v247, 0, v28
    s_mov_b32 s99, 1
L_nr1_6:
    v_exp_f32 v176, v160
    v_exp_f32 v177, v161
    v_exp_f32 v178, v162
    v_mfma_f32_32x32x16_bf16 v[64:79], v[216:219], v[196:199], v[64:79]
    v_exp_f32 v179, v163
    v_exp_f32 v180, v164
    v_exp_f32 v181, v165
    ds_read_b128 v[216:219], v36 offset:49152
    buffer_load_dwordx4 v8, s[72:75], s91 offen offset:2048 nt lds
    v_mfma_f32_32x32x16_bf16 v[80:95], v[220:223], v[196:199], v[80:95]
    v_exp_f32 v182, v166
    v_exp_f32 v183, v167
    v_exp_f32 v184, v168
    ds_read_b128 v[220:223], v37 offset:49152
    v_mfma_f32_32x32x16_bf16 v[96:111], v[224:227], v[196:199], v[96:111]
    v_exp_f32 v185, v169
    v_exp_f32 v186, v170
    v_exp_f32 v187, v171
    ds_read_b128 v[224:227], v38 offset:49152
    buffer_load_dwordx4 v9, s[72:75], s91 offen offset:3072 nt lds
    v_mfma_f32_32x32x16_bf16 v[112:127], v[228:231], v[196:199], v[112:127]
    ds_read_b128 v[228:231], v39 offset:49152
    v_exp_f32 v188, v172
    v_exp_f32 v189, v173
    v_exp_f32 v190, v174
    v_exp_f32 v191, v175
    s_cmp_eq_u32 s99, 0
    s_cbranch_scc1 L_nr2_7
    s_nop 15
    v_mul_f32 v29, v29, v30
    v_mul_f32 v64, v64, v30
    v_mul_f32 v65, v65, v30
    v_mul_f32 v66, v66, v30
    v_mul_f32 v67, v67, v30
    v_mul_f32 v68, v68, v30
    v_mul_f32 v69, v69, v30
    v_mul_f32 v70, v70, v30
    v_mul_f32 v71, v71, v30
    v_mul_f32 v72, v72, v30
    v_mul_f32 v73, v73, v30
    v_mul_f32 v74, v74, v30
    v_mul_f32 v75, v75, v30
    v_mul_f32 v76, v76, v30
    v_mul_f32 v77, v77, v30
    v_mul_f32 v78, v78, v30
    v_mul_f32 v79, v79, v30
    v_mul_f32 v80, v80, v30
    v_mul_f32 v81, v81, v30
    v_mul_f32 v82, v82, v30
    v_mul_f32 v83, v83, v30
    v_mul_f32 v84, v84, v30
    v_mul_f32 v85, v85, v30
    v_mul_f32 v86, v86, v30
    v_mul_f32 v87, v87, v30
    v_mul_f32 v88, v88, v30
    v_mul_f32 v89, v89, v30
    v_mul_f32 v90, v90, v30
    v_mul_f32 v91, v91, v30
    v_mul_f32 v92, v92, v30
    v_mul_f32 v93, v93, v30
    v_mul_f32 v94, v94, v30
    v_mul_f32 v95, v95, v30
    v_mul_f32 v96, v96, v30
    v_mul_f32 v97, v97, v30
    v_mul_f32 v98, v98, v30
    v_mul_f32 v99, v99, v30
    v_mul_f32 v100, v100, v30
    v_mul_f32 v101, v101, v30
    v_mul_f32 v102, v102, v30
    v_mul_f32 v103, v103, v30
    v_mul_f32 v104, v104, v30
    v_mul_f32 v105, v105, v30
    v_mul_f32 v106, v106, v30
    v_mul_f32 v107, v107, v30
    v_mul_f32 v108, v108, v30
    v_mul_f32 v109, v109, v30
    v_mul_f32 v110, v110, v30
    v_mul_f32 v111, v111, v30
    v_mul_f32 v112, v112, v30
    v_mul_f32 v113, v113, v30
    v_mul_f32 v114, v114, v30
    v_mul_f32 v115, v115, v30
    v_mul_f32 v116, v116, v30
    v_mul_f32 v117, v117, v30
    v_mul_f32 v118, v118, v30
    v_mul_f32 v119, v119, v30
    v_mul_f32 v120, v120, v30
    v_mul_f32 v121, v121, v30
    v_mul_f32 v122, v122, v30
    v_mul_f32 v123, v123, v30
    v_mul_f32 v124, v124, v30
    v_mul_f32 v125, v125, v30
    v_mul_f32 v126, v126, v30
    v_mul_f32 v127, v127, v30
    s_mov_b32 s99, 0
L_nr2_7:
    s_add_u32 s91, s91, 16384
    s_and_b32 s91, s91, 0x3ffff
    s_cmp_eq_u32 s89, 2
    s_cbranch_scc1 L_v12
L_vback2:
    s_waitcnt vmcnt(12) lgkmcnt(0)
    s_barrier
    s_add_u32 m0, s98, 49152
    v_mfma_f32_32x32x16_bf16 v[160:175], v[200:203], v[128:131], v[232:247]
    v_add_f32 v40, v176, v177
    v_add_f32 v41, v178, v179
    v_add_f32 v40, v40, v180
    v_add_u32 v43, 0x10000, v248
    ds_read_b64_tr_b16 v[200:201], v43 offset:0
    v_add_u32 v42, 0x10000, v249
    ds_read_b64_tr_b16 v[202:203], v42 offset:2048
    v_mfma_f32_32x32x16_bf16 v[160:175], v[204:207], v[132:135], v[160:175]
    v_add_f32 v41, v41, v181
    v_add_f32 v40, v40, v182
    v_add_f32 v41, v41, v183
    v_add_u32 v43, 0x10000, v250
    ds_read_b64_tr_b16 v[204:205], v43 offset:0
    v_add_u32 v42, 0x10000, v251
    ds_read_b64_tr_b16 v[206:207], v42 offset:2048
    buffer_load_dwordx4 v2, s[68:71], s90 offen offset:0 nt lds
    v_mfma_f32_32x32x16_bf16 v[160:175], v[208:211], v[136:139], v[160:175]
    v_add_f32 v40, v40, v184
    v_add_f32 v41, v41, v185
    v_add_f32 v40, v40, v186
    v_add_u32 v43, 0x10000, v252
    ds_read_b64_tr_b16 v[208:209], v43 offset:0
    v_add_u32 v42, 0x10000, v253
    ds_read_b64_tr_b16 v[210:211], v42 offset:2048
    v_mfma_f32_32x32x16_bf16 v[160:175], v[212:215], v[140:143], v[160:175]
    v_add_f32 v41, v41, v187
    v_add_f32 v40, v40, v188
    v_add_f32 v41, v41, v189
    v_add_u32 v43, 0x10000, v254
    ds_read_b64_tr_b16 v[212:213], v43 offset:0
    v_add_u32 v42, 0x10000, v255
    ds_read_b64_tr_b16 v[214:215], v42 offset:2048
    buffer_load_dwordx4 v3, s[68:71], s90 offen offset:1024 nt lds
    v_mfma_f32_32x32x16_bf16 v[160:175], v[216:219], v[144:147], v[160:175]
    v_add_f32 v40, v40, v190
    v_add_f32 v41, v41, v191
    v_cvt_pk_bf16_f32 v192, v176, v177
    v_add_u32 v43, 0x10000, v248
    ds_read_b64_tr_b16 v[216:217], v43 offset:4096
    v_add_u32 v42, 0x10000, v249
    ds_read_b64_tr_b16 v[218:219], v42 offset:6144
    buffer_load_dwordx4 v4, s[68:71], s90 offen offset:2048 nt lds
    v_mfma_f32_32x32x16_bf16 v[160:175], v[220:223], v[148:151], v[160:175]
    v_cvt_pk_bf16_f32 v193, v178, v179
    v_cvt_pk_bf16_f32 v194, v180, v181
    v_cvt_pk_bf16_f32 v195, v182, v183
    v_add_u32 v43, 0x10000, v250
    ds_read_b64_tr_b16 v[220:221], v43 offset:4096
    v_add_u32 v42, 0x10000, v251
    ds_read_b64_tr_b16 v[222:223], v42 offset:6144
    v_mfma_f32_32x32x16_bf16 v[160:175], v[224:227], v[152:155], v[160:175]
    v_cvt_pk_bf16_f32 v196, v184, v185
    v_cvt_pk_bf16_f32 v197, v186, v187
    v_cvt_pk_bf16_f32 v198, v188, v189
    v_add_u32 v43, 0x10000, v252
    ds_read_b64_tr_b16 v[224:225], v43 offset:4096
    v_add_u32 v42, 0x10000, v253
    ds_read_b64_tr_b16 v[226:227], v42 offset:6144
    buffer_load_dwordx4 v5, s[68:71], s90 offen offset:3072 nt lds
    v_mfma_f32_32x32x16_bf16 v[160:175], v[228:231], v[156:159], v[160:175]
    v_cvt_pk_bf16_f32 v199, v190, v191
    v_add_f32 v40, v40, v41
    v_add_f32 v29, v29, v40
    v_add_u32 v43, 0x10000, v254
    ds_read_b64_tr_b16 v[228:229], v43 offset:4096
    v_add_u32 v42, 0x10000, v255
    ds_read_b64_tr_b16 v[230:231], v42 offset:6144
    s_add_u32 s90, s90, 16384
    s_and_b32 s90, s90, 0x3ffff
    s_cmp_eq_u32 s89, 2
    s_cbranch_scc1 L_k13
L_kback3:
    s_waitcnt vmcnt(12) lgkmcnt(0)
    s_barrier
    s_add_u32 m0, s98, 65536
    v_mfma_f32_32x32x16_bf16 v[64:79], v[200:203], v[192:195], v[64:79]
    ds_read_b128 v[200:203], v32 offset:0
    buffer_load_dwordx4 v6, s[72:75], s91 offen offset:0 nt lds
    v_max3_f32 v40, v160, v161, v162
    v_max3_f32 v41, v163, v164, v165
    v_max3_f32 v40, v40, v166, v167
    v_max3_f32 v41, v41, v168, v169
    v_mfma_f32_32x32x16_bf16 v[80:95], v[204:207], v[192:195], v[80:95]
    v_max3_f32 v40, v40, v170, v171
    v_max3_f32 v41, v41, v172, v173
    v_max3_f32 v40, v40, v174, v175
    v_max_f32 v40, v40, v41
    v_mov_b32 v41, v40
    ds_read_b128 v[204:207], v33 offset:0
    v_mfma_f32_32x32x16_bf16 v[96:111], v[208:211], v[192:195], v[96:111]
    ds_read_b128 v[208:211], v34 offset:0
    v_permlane32_swap_b32 v40, v41
    v_max_f32 v40, v40, v41
    v_cmp_lt_f32 vcc, s93, v40
    buffer_load_dwordx4 v7, s[72:75], s91 offen offset:1024 nt lds
    v_mfma_f32_32x32x16_bf16 v[112:127], v[212:215], v[192:195], v[112:127]
    ds_read_b128 v[212:215], v35 offset:0
    s_cbranch_vccz L_nr1_8
    v_max_f32 v40, 0, v40
    v_exp_f32 v30, -v40
    v_add_f32 v28, v28, v40
    v_sub_f32 v160, v160, v40
    v_sub_f32 v161, v161, v40
    v_sub_f32 v162, v162, v40
    v_sub_f32 v163, v163, v40
    v_sub_f32 v164, v164, v40
    v_sub_f32 v165, v165, v40
    v_sub_f32 v166, v166, v40
    v_sub_f32 v167, v167, v40
    v_sub_f32 v168, v168, v40
    v_sub_f32 v169, v169, v40
    v_sub_f32 v170, v170, v40
    v_sub_f32 v171, v171, v40
    v_sub_f32 v172, v172, v40
    v_sub_f32 v173, v173, v40
    v_sub_f32 v174, v174, v40
    v_sub_f32 v175, v175, v40
    v_sub_f32 v232, 0, v28
    v_sub_f32 v233, 0, v28
    v_sub_f32 v234, 0, v28
    v_sub_f32 v235, 0, v28
    v_sub_f32 v236, 0, v28
    v_sub_f32 v237, 0, v28
    v_sub_f32 v238, 0, v28
    v_sub_f32 v239, 0, v28
    v_sub_f32 v240, 0, v28
    v_sub_f32 v241, 0, v28
    v_sub_f32 v242, 0, v28
    v_sub_f32 v243, 0, v28
    v_sub_f32 v244, 0, v28
    v_sub_f32 v245, 0, v28
    v_sub_f32 v246, 0, v28
    v_sub_f32 v247, 0, v28
    s_mov_b32 s99, 1
L_nr1_8:
    v_exp_f32 v176, v160
    v_exp_f32 v177, v161
    v_exp_f32 v178, v162
    v_mfma_f32_32x32x16_bf16 v[64:79], v[216:219], v[196:199], v[64:79]
    v_exp_f32 v179, v163
    v_exp_f32 v180, v164
    v_exp_f32 v181, v165
    ds_read_b128 v[216:219], v36 offset:0
    buffer_load_dwordx4 v8, s[72:75], s91 offen offset:2048 nt lds
    v_mfma_f32_32x32x16_bf16 v[80:95], v[220:223], v[196:199], v[80:95]
    v_exp_f32 v182, v166
    v_exp_f32 v183, v167
    v_exp_f32 v184, v168
    ds_read_b128 v[220:223], v37 offset:0
    v_mfma_f32_32x32x16_bf16 v[96:111], v[224:227], v[196:199], v[96:111]
    v_exp_f32 v185, v169
    v_exp_f32 v186, v170
    v_exp_f32 v187, v171
    ds_read_b128 v[224:227], v38 offset:0
    buffer_load_dwordx4 v9, s[72:75], s91 offen offset:3072 nt lds
    v_mfma_f32_32x32x16_bf16 v[112:127], v[228:231], v[196:199], v[112:127]
    ds_read_b128 v[228:231], v39 offset:0
    v_exp_f32 v188, v172
    v_exp_f32 v189, v173
    v_exp_f32 v190, v174
    v_exp_f32 v191, v175
    s_cmp_eq_u32 s99, 0
    s_cbranch_scc1 L_nr2_9
    s_nop 15
    v_mul_f32 v29, v29, v30
    v_mul_f32 v64, v64, v30
    v_mul_f32 v65, v65, v30
    v_mul_f32 v66, v66, v30
    v_mul_f32 v67, v67, v30
    v_mul_f32 v68, v68, v30
    v_mul_f32 v69, v69, v30
    v_mul_f32 v70, v70, v30
    v_mul_f32 v71, v71, v30
    v_mul_f32 v72, v72, v30
    v_mul_f32 v73, v73, v30
    v_mul_f32 v74, v74, v30
    v_mul_f32 v75, v75, v30
    v_mul_f32 v76, v76, v30
    v_mul_f32 v77, v77, v30
    v_mul_f32 v78, v78, v30
    v_mul_f32 v79, v79, v30
    v_mul_f32 v80, v80, v30
    v_mul_f32 v81, v81, v30
    v_mul_f32 v82, v82, v30
    v_mul_f32 v83, v83, v30
    v_mul_f32 v84, v84, v30
    v_mul_f32 v85, v85, v30
    v_mul_f32 v86, v86, v30
    v_mul_f32 v87, v87, v30
    v_mul_f32 v88, v88, v30
    v_mul_f32 v89, v89, v30
    v_mul_f32 v90, v90, v30
    v_mul_f32 v91, v91, v30
    v_mul_f32 v92, v92, v30
    v_mul_f32 v93, v93, v30
    v_mul_f32 v94, v94, v30
    v_mul_f32 v95, v95, v30
    v_mul_f32 v96, v96, v30
    v_mul_f32 v97, v97, v30
    v_mul_f32 v98, v98, v30
    v_mul_f32 v99, v99, v30
    v_mul_f32 v100, v100, v30
    v_mul_f32 v101, v101, v30
    v_mul_f32 v102, v102, v30
    v_mul_f32 v103, v103, v30
    v_mul_f32 v104, v104, v30
    v_mul_f32 v105, v105, v30
    v_mul_f32 v106, v106, v30
    v_mul_f32 v107, v107, v30
    v_mul_f32 v108, v108, v30
    v_mul_f32 v109, v109, v30
    v_mul_f32 v110, v110, v30
    v_mul_f32 v111, v111, v30
    v_mul_f32 v112, v112, v30
    v_mul_f32 v113, v113, v30
    v_mul_f32 v114, v114, v30
    v_mul_f32 v115, v115, v30
    v_mul_f32 v116, v116, v30
    v_mul_f32 v117, v117, v30
    v_mul_f32 v118, v118, v30
    v_mul_f32 v119, v119, v30
    v_mul_f32 v120, v120, v30
    v_mul_f32 v121, v121, v30
    v_mul_f32 v122, v122, v30
    v_mul_f32 v123, v123, v30
    v_mul_f32 v124, v124, v30
    v_mul_f32 v125, v125, v30
    v_mul_f32 v126, v126, v30
    v_mul_f32 v127, v127, v30
    s_mov_b32 s99, 0
L_nr2_9:
    s_add_u32 s91, s91, 16384
    s_and_b32 s91, s91, 0x3ffff
    s_waitcnt vmcnt(12) lgkmcnt(0)
    s_barrier
    s_add_u32 m0, s98, 0
    v_mfma_f32_32x32x16_bf16 v[160:175], v[200:203], v[128:131], v[232:247]
    v_add_f32 v40, v176, v177
    v_add_f32 v41, v178, v179
    v_add_f32 v40, v40, v180
    ds_read_b64_tr_b16 v[200:201], v248 offset:16384
    ds_read_b64_tr_b16 v[202:203], v249 offset:18432
    v_mfma_f32_32x32x16_bf16 v[160:175], v[204:207], v[132:135], v[160:175]
    v_add_f32 v41, v41, v181
    v_add_f32 v40, v40, v182
    v_add_f32 v41, v41, v183
    ds_read_b64_tr_b16 v[204:205], v250 offset:16384
    ds_read_b64_tr_b16 v[206:207], v251 offset:18432
    buffer_load_dwordx4 v2, s[68:71], s90 offen offset:0 nt lds
    v_mfma_f32_32x32x16_bf16 v[160:175], v[208:211], v[136:139], v[160:175]
    v_add_f32 v40, v40, v184
    v_add_f32 v41, v41, v185
    v_add_f32 v40, v40, v186
    ds_read_b64_tr_b16 v[208:209], v252 offset:16384
    ds_read_b64_tr_b16 v[210:211], v253 offset:18432
    v_mfma_f32_32x32x16_bf16 v[160:175], v[212:215], v[140:143], v[160:175]
    v_add_f32 v41, v41, v187
    v_add_f32 v40, v40, v188
    v_add_f32 v41, v41, v189
    ds_read_b64_tr_b16 v[212:213], v254 offset:16384
    ds_read_b64_tr_b16 v[214:215], v255 offset:18432
    buffer_load_dwordx4 v3, s[68:71], s90 offen offset:1024 nt lds
    v_mfma_f32_32x32x16_bf16 v[160:175], v[216:219], v[144:147], v[160:175]
    v_add_f32 v40, v40, v190
    v_add_f32 v41, v41, v191
    v_cvt_pk_bf16_f32 v192, v176, v177
    ds_read_b64_tr_b16 v[216:217], v248 offset:20480
    ds_read_b64_tr_b16 v[218:219], v249 offset:22528
    buffer_load_dwordx4 v4, s[68:71], s90 offen offset:2048 nt lds
    v_mfma_f32_32x32x16_bf16 v[160:175], v[220:223], v[148:151], v[160:175]
    v_cvt_pk_bf16_f32 v193, v178, v179
    v_cvt_pk_bf16_f32 v194, v180, v181
    v_cvt_pk_bf16_f32 v195, v182, v183
    ds_read_b64_tr_b16 v[220:221], v250 offset:20480
    ds_read_b64_tr_b16 v[222:223], v251 offset:22528
    v_mfma_f32_32x32x16_bf16 v[160:175], v[224:227], v[152:155], v[160:175]
    v_cvt_pk_bf16_f32 v196, v184, v185
    v_cvt_pk_bf16_f32 v197, v186, v187
    v_cvt_pk_bf16_f32 v198, v188, v189
    ds_read_b64_tr_b16 v[224:225], v252 offset:20480
    ds_read_b64_tr_b16 v[226:227], v253 offset:22528
    buffer_load_dwordx4 v5, s[68:71], s90 offen offset:3072 nt lds
    v_mfma_f32_32x32x16_bf16 v[160:175], v[228:231], v[156:159], v[160:175]
    v_cvt_pk_bf16_f32 v199, v190, v191
    v_add_f32 v40, v40, v41
    v_add_f32 v29, v29, v40
    ds_read_b64_tr_b16 v[228:229], v254 offset:20480
    ds_read_b64_tr_b16 v[230:231], v255 offset:22528
    s_add_u32 s90, s90, 16384
    s_and_b32 s90, s90, 0x3ffff
    s_cmp_eq_u32 s89, 2
    s_cbranch_scc1 L_loop_exit
L_kback4:
    s_waitcnt vmcnt(12) lgkmcnt(0)
    s_barrier
    s_add_u32 m0, s98, 16384
    v_mfma_f32_32x32x16_bf16 v[64:79], v[200:203], v[192:195], v[64:79]
    ds_read_b128 v[200:203], v32 offset:32768
    buffer_load_dwordx4 v6, s[72:75], s91 offen offset:0 nt lds
    v_max3_f32 v40, v160, v161, v162
    v_max3_f32 v41, v163, v164, v165
    v_max3_f32 v40, v40, v166, v167
    v_max3_f32 v41, v41, v168, v169
    v_mfma_f32_32x32x16_bf16 v[80:95], v[204:207], v[192:195], v[80:95]
    v_max3_f32 v40, v40, v170, v171
    v_max3_f32 v41, v41, v172, v173
    v_max3_f32 v40, v40, v174, v175
    v_max_f32 v40, v40, v41
    v_mov_b32 v41, v40
    ds_read_b128 v[204:207], v33 offset:32768
    v_mfma_f32_32x32x16_bf16 v[96:111], v[208:211], v[192:195], v[96:111]
    ds_read_b128 v[208:211], v34 offset:32768
    v_permlane32_swap_b32 v40, v41
    v_max_f32 v40, v40, v41
    v_cmp_lt_f32 vcc, s93, v40
    buffer_load_dwordx4 v7, s[72:75], s91 offen offset:1024 nt lds
    v_mfma_f32_32x32x16_bf16 v[112:127], v[212:215], v[192:195], v[112:127]
    ds_read_b128 v[212:215], v35 offset:32768
    s_cbranch_vccz L_nr1_10
    v_max_f32 v40, 0, v40
    v_exp_f32 v30, -v40
    v_add_f32 v28, v28, v40
    v_sub_f32 v160, v160, v40
    v_sub_f32 v161, v161, v40
    v_sub_f32 v162, v162, v40
    v_sub_f32 v163, v163, v40
    v_sub_f32 v164, v164, v40
    v_sub_f32 v165, v165, v40
    v_sub_f32 v166, v166, v40
    v_sub_f32 v167, v167, v40
    v_sub_f32 v168, v168, v40
    v_sub_f32 v169, v169, v40
    v_sub_f32 v170, v170, v40
    v_sub_f32 v171, v171, v40
    v_sub_f32 v172, v172, v40
    v_sub_f32 v173, v173, v40
    v_sub_f32 v174, v174, v40
    v_sub_f32 v175, v175, v40
    v_sub_f32 v232, 0, v28
    v_sub_f32 v233, 0, v28
    v_sub_f32 v234, 0, v28
    v_sub_f32 v235, 0, v28
    v_sub_f32 v236, 0, v28
    v_sub_f32 v237, 0, v28
    v_sub_f32 v238, 0, v28
    v_sub_f32 v239, 0, v28
    v_sub_f32 v240, 0, v28
    v_sub_f32 v241, 0, v28
    v_sub_f32 v242, 0, v28
    v_sub_f32 v243, 0, v28
    v_sub_f32 v244, 0, v28
    v_sub_f32 v245, 0, v28
    v_sub_f32 v246, 0, v28
    v_sub_f32 v247, 0, v28
    s_mov_b32 s99, 1
L_nr1_10:
    v_exp_f32 v176, v160
    v_exp_f32 v177, v161
    v_exp_f32 v178, v162
    v_mfma_f32_32x32x16_bf16 v[64:79], v[216:219], v[196:199], v[64:79]
    v_exp_f32 v179, v163
    v_exp_f32 v180, v164
    v_exp_f32 v181, v165
    ds_read_b128 v[216:219], v36 offset:32768
    buffer_load_dwordx4 v8, s[72:75], s91 offen offset:2048 nt lds
    v_mfma_f32_32x32x16_bf16 v[80:95], v[220:223], v[196:199], v[80:95]
    v_exp_f32 v182, v166
    v_exp_f32 v183, v167
    v_exp_f32 v184, v168
    ds_read_b128 v[220:223], v37 offset:32768
    v_mfma_f32_32x32x16_bf16 v[96:111], v[224:227], v[196:199], v[96:111]
    v_exp_f32 v185, v169
    v_exp_f32 v186, v170
    v_exp_f32 v187, v171
    ds_read_b128 v[224:227], v38 offset:32768
    buffer_load_dwordx4 v9, s[72:75], s91 offen offset:3072 nt lds
    v_mfma_f32_32x32x16_bf16 v[112:127], v[228:231], v[196:199], v[112:127]
    ds_read_b128 v[228:231], v39 offset:32768
    v_exp_f32 v188, v172
    v_exp_f32 v189, v173
    v_exp_f32 v190, v174
    v_exp_f32 v191, v175
    s_cmp_eq_u32 s99, 0
    s_cbranch_scc1 L_nr2_11
    s_nop 15
    v_mul_f32 v29, v29, v30
    v_mul_f32 v64, v64, v30
    v_mul_f32 v65, v65, v30
    v_mul_f32 v66, v66, v30
    v_mul_f32 v67, v67, v30
    v_mul_f32 v68, v68, v30
    v_mul_f32 v69, v69, v30
    v_mul_f32 v70, v70, v30
    v_mul_f32 v71, v71, v30
    v_mul_f32 v72, v72, v30
    v_mul_f32 v73, v73, v30
    v_mul_f32 v74, v74, v30
    v_mul_f32 v75, v75, v30
    v_mul_f32 v76, v76, v30
    v_mul_f32 v77, v77, v30
    v_mul_f32 v78, v78, v30
    v_mul_f32 v79, v79, v30
    v_mul_f32 v80, v80, v30
    v_mul_f32 v81, v81, v30
    v_mul_f32 v82, v82, v30
    v_mul_f32 v83, v83, v30
    v_mul_f32 v84, v84, v30
    v_mul_f32 v85, v85, v30
    v_mul_f32 v86, v86, v30
    v_mul_f32 v87, v87, v30
    v_mul_f32 v88, v88, v30
    v_mul_f32 v89, v89, v30
    v_mul_f32 v90, v90, v30
    v_mul_f32 v91, v91, v30
    v_mul_f32 v92, v92, v30
    v_mul_f32 v93, v93, v30
    v_mul_f32 v94, v94, v30
    v_mul_f32 v95, v95, v30
    v_mul_f32 v96, v96, v30
    v_mul_f32 v97, v97, v30
    v_mul_f32 v98, v98, v30
    v_mul_f32 v99, v99, v30
    v_mul_f32 v100, v100, v30
    v_mul_f32 v101, v101, v30
    v_mul_f32 v102, v102, v30
    v_mul_f32 v103, v103, v30
    v_mul_f32 v104, v104, v30
    v_mul_f32 v105, v105, v30
    v_mul_f32 v106, v106, v30
    v_mul_f32 v107, v107, v30
    v_mul_f32 v108, v108, v30
    v_mul_f32 v109, v109, v30
    v_mul_f32 v110, v110, v30
    v_mul_f32 v111, v111, v30
    v_mul_f32 v112, v112, v30
    v_mul_f32 v113, v113, v30
    v_mul_f32 v114, v114, v30
    v_mul_f32 v115, v115, v30
    v_mul_f32 v116, v116, v30
    v_mul_f32 v117, v117, v30
    v_mul_f32 v118, v118, v30
    v_mul_f32 v119, v119, v30
    v_mul_f32 v120, v120, v30
    v_mul_f32 v121, v121, v30
    v_mul_f32 v122, v122, v30
    v_mul_f32 v123, v123, v30
    v_mul_f32 v124, v124, v30
    v_mul_f32 v125, v125, v30
    v_mul_f32 v126, v126, v30
    v_mul_f32 v127, v127, v30
    s_mov_b32 s99, 0
L_nr2_11:
    s_add_u32 s91, s91, 16384
    s_and_b32 s91, s91, 0x3ffff
    s_add_u32 s89, s89, 1
    s_waitcnt vmcnt(12) lgkmcnt(0)
    s_barrier
    s_branch L_loop
L_v11:
    s_mov_b32 s72, s44
    s_mov_b32 s73, s45
    s_mov_b32 s74, s46
    s_add_u32 s91, s3, 245760
    s_and_b32 s91, s91, 0x3ffff
    s_branch L_vback1
L_v12:
    s_mov_b32 s72, s48
    s_mov_b32 s73, s49
    s_mov_b32 s74, s50
    s_add_u32 s91, s81, 1
    s_and_b32 s91, s91, 3
    s_lshl_b32 s91, s91, 1
    s_add_u32 s91, s91, s101
    s_lshl_b32 s91, s91, 16
    v_mov_b32 v6, v10
    v_mov_b32 v7, v11
    v_mov_b32 v8, v12
    v_mov_b32 v9, v13
    s_branch L_vback2
L_k12:
    s_mov_b32 s68, s48
    s_mov_b32 s69, s49
    s_mov_b32 s70, s50
    s_add_u32 s90, s81, 0
    s_and_b32 s90, s90, 3
    s_lshl_b32 s90, s90, 1
    s_add_u32 s90, s90, s101
    s_lshl_b32 s90, s90, 16
    v_mov_b32 v2, v10
    v_mov_b32 v3, v11
    v_mov_b32 v4, v12
    v_mov_b32 v5, v13
    s_branch L_kback2
L_k13:
    s_add_u32 s90, s81, 2
    s_and_b32 s90, s90, 3
    s_lshl_b32 s90, s90, 1
    s_add_u32 s90, s90, s101
    s_lshl_b32 s90, s90, 16
    s_branch L_kback3
L_loop_exit:
    s_waitcnt vmcnt(12) lgkmcnt(0)
    s_barrier
    v_mov_b32 v43, 0
    buffer_load_dwordx2 v[46:47], v43, s[76:79], 0 offen sc1
    s_add_u32 s88, s81, 3
    s_and_b32 s88, s88, 3
    s_lshl_b32 s88, s88, 1
    s_add_u32 s88, s88, s101
    s_lshl_b32 s88, s88, 16
    buffer_load_dwordx4 v[48:51], v10, s[48:51], s88 offen offset:0
    buffer_load_dwordx4 v[52:55], v11, s[48:51], s88 offen offset:1024
    buffer_load_dwordx4 v[56:59], v12, s[48:51], s88 offen offset:2048
    buffer_load_dwordx4 v[60:63], v13, s[48:51], s88 offen offset:3072
    v_mfma_f32_32x32x16_bf16 v[64:79], v[200:203], v[192:195], v[64:79]
    ds_read_b64_tr_b16 v[200:201], v248 offset:32768
    ds_read_b64_tr_b16 v[202:203], v249 offset:34816
    v_max3_f32 v40, v160, v161, v162
    v_max3_f32 v41, v163, v164, v165
    v_max3_f32 v40, v40, v166, v167
    v_max3_f32 v41, v41, v168, v169
    v_mfma_f32_32x32x16_bf16 v[80:95], v[204:207], v[192:195], v[80:95]
    v_max3_f32 v40, v40, v170, v171
    v_max3_f32 v41, v41, v172, v173
    v_max3_f32 v40, v40, v174, v175
    v_max_f32 v40, v40, v41
    v_mov_b32 v41, v40
    ds_read_b64_tr_b16 v[204:205], v250 offset:32768
    ds_read_b64_tr_b16 v[206:207], v251 offset:34816
    v_mfma_f32_32x32x16_bf16 v[96:111], v[208:211], v[192:195], v[96:111]
    ds_read_b64_tr_b16 v[208:209], v252 offset:32768
    ds_read_b64_tr_b16 v[210:211], v253 offset:34816
    v_permlane32_swap_b32 v40, v41
    v_max_f32 v40, v40, v41
    v_cmp_lt_f32 vcc, s93, v40
    v_mfma_f32_32x32x16_bf16 v[112:127], v[212:215], v[192:195], v[112:127]
    ds_read_b64_tr_b16 v[212:213], v254 offset:32768
    ds_read_b64_tr_b16 v[214:215], v255 offset:34816
    s_cbranch_vccz L_nr1_12
    v_max_f32 v40, 0, v40
    v_exp_f32 v30, -v40
    v_add_f32 v28, v28, v40
    v_sub_f32 v160, v160, v40
    v_sub_f32 v161, v161, v40
    v_sub_f32 v162, v162, v40
    v_sub_f32 v163, v163, v40
    v_sub_f32 v164, v164, v40
    v_sub_f32 v165, v165, v40
    v_sub_f32 v166, v166, v40
    v_sub_f32 v167, v167, v40
    v_sub_f32 v168, v168, v40
    v_sub_f32 v169, v169, v40
    v_sub_f32 v170, v170, v40
    v_sub_f32 v171, v171, v40
    v_sub_f32 v172, v172, v40
    v_sub_f32 v173, v173, v40
    v_sub_f32 v174, v174, v40
    v_sub_f32 v175, v175, v40
    v_sub_f32 v232, 0, v28
    v_sub_f32 v233, 0, v28
    v_sub_f32 v234, 0, v28
    v_sub_f32 v235, 0, v28
    v_sub_f32 v236, 0, v28
    v_sub_f32 v237, 0, v28
    v_sub_f32 v238, 0, v28
    v_sub_f32 v239, 0, v28
    v_sub_f32 v240, 0, v28
    v_sub_f32 v241, 0, v28
    v_sub_f32 v242, 0, v28
    v_sub_f32 v243, 0, v28
    v_sub_f32 v244, 0, v28
    v_sub_f32 v245, 0, v28
    v_sub_f32 v246, 0, v28
    v_sub_f32 v247, 0, v28
    s_mov_b32 s99, 1
L_nr1_12:
    v_exp_f32 v176, v160
    v_exp_f32 v177, v161
    v_exp_f32 v178, v162
    v_mfma_f32_32x32x16_bf16 v[64:79], v[216:219], v[196:199], v[64:79]
    v_exp_f32 v179, v163
    v_exp_f32 v180, v164
    v_exp_f32 v181, v165
    ds_read_b64_tr_b16 v[216:217], v248 offset:36864
    ds_read_b64_tr_b16 v[218:219], v249 offset:38912
    v_mfma_f32_32x32x16_bf16 v[80:95], v[220:223], v[196:199], v[80:95]
    v_exp_f32 v182, v166
    v_exp_f32 v183, v167
    v_exp_f32 v184, v168
    ds_read_b64_tr_b16 v[220:221], v250 offset:36864
    ds_read_b64_tr_b16 v[222:223], v251 offset:38912
    v_mfma_f32_32x32x16_bf16 v[96:111], v[224:227], v[196:199], v[96:111]
    v_exp_f32 v185, v169
    v_exp_f32 v186, v170
    v_exp_f32 v187, v171
    ds_read_b64_tr_b16 v[224:225], v252 offset:36864
    ds_read_b64_tr_b16 v[226:227], v253 offset:38912
    v_mfma_f32_32x32x16_bf16 v[112:127], v[228:231], v[196:199], v[112:127]
    ds_read_b64_tr_b16 v[228:229], v254 offset:36864
    ds_read_b64_tr_b16 v[230:231], v255 offset:38912
    v_exp_f32 v188, v172
    v_exp_f32 v189, v173
    v_exp_f32 v190, v174
    v_exp_f32 v191, v175
    s_cmp_eq_u32 s99, 0
    s_cbranch_scc1 L_nr2_13
    s_nop 15
    v_mul_f32 v29, v29, v30
    v_mul_f32 v64, v64, v30
    v_mul_f32 v65, v65, v30
    v_mul_f32 v66, v66, v30
    v_mul_f32 v67, v67, v30
    v_mul_f32 v68, v68, v30
    v_mul_f32 v69, v69, v30
    v_mul_f32 v70, v70, v30
    v_mul_f32 v71, v71, v30
    v_mul_f32 v72, v72, v30
    v_mul_f32 v73, v73, v30
    v_mul_f32 v74, v74, v30
    v_mul_f32 v75, v75, v30
    v_mul_f32 v76, v76, v30
    v_mul_f32 v77, v77, v30
    v_mul_f32 v78, v78, v30
    v_mul_f32 v79, v79, v30
    v_mul_f32 v80, v80, v30
    v_mul_f32 v81, v81, v30
    v_mul_f32 v82, v82, v30
    v_mul_f32 v83, v83, v30
    v_mul_f32 v84, v84, v30
    v_mul_f32 v85, v85, v30
    v_mul_f32 v86, v86, v30
    v_mul_f32 v87, v87, v30
    v_mul_f32 v88, v88, v30
    v_mul_f32 v89, v89, v30
    v_mul_f32 v90, v90, v30
    v_mul_f32 v91, v91, v30
    v_mul_f32 v92, v92, v30
    v_mul_f32 v93, v93, v30
    v_mul_f32 v94, v94, v30
    v_mul_f32 v95, v95, v30
    v_mul_f32 v96, v96, v30
    v_mul_f32 v97, v97, v30
    v_mul_f32 v98, v98, v30
    v_mul_f32 v99, v99, v30
    v_mul_f32 v100, v100, v30
    v_mul_f32 v101, v101, v30
    v_mul_f32 v102, v102, v30
    v_mul_f32 v103, v103, v30
    v_mul_f32 v104, v104, v30
    v_mul_f32 v105, v105, v30
    v_mul_f32 v106, v106, v30
    v_mul_f32 v107, v107, v30
    v_mul_f32 v108, v108, v30
    v_mul_f32 v109, v109, v30
    v_mul_f32 v110, v110, v30
    v_mul_f32 v111, v111, v30
    v_mul_f32 v112, v112, v30
    v_mul_f32 v113, v113, v30
    v_mul_f32 v114, v114, v30
    v_mul_f32 v115, v115, v30
    v_mul_f32 v116, v116, v30
    v_mul_f32 v117, v117, v30
    v_mul_f32 v118, v118, v30
    v_mul_f32 v119, v119, v30
    v_mul_f32 v120, v120, v30
    v_mul_f32 v121, v121, v30
    v_mul_f32 v122, v122, v30
    v_mul_f32 v123, v123, v30
    v_mul_f32 v124, v124, v30
    v_mul_f32 v125, v125, v30
    v_mul_f32 v126, v126, v30
    v_mul_f32 v127, v127, v30
    s_mov_b32 s99, 0
L_nr2_13:
    v_add_f32 v40, v176, v177
    v_add_f32 v41, v178, v179
    v_add_f32 v40, v40, v180
    v_add_f32 v41, v41, v181
    v_add_f32 v40, v40, v182
    v_add_f32 v41, v41, v183
    v_add_f32 v40, v40, v184
    v_add_f32 v41, v41, v185
    v_add_f32 v40, v40, v186
    v_add_f32 v41, v41, v187
    v_add_f32 v40, v40, v188
    v_add_f32 v41, v41, v189
    v_add_f32 v40, v40, v190
    v_add_f32 v41, v41, v191
    v_add_f32 v40, v40, v41
    v_add_f32 v29, v29, v40
    v_cvt_pk_bf16_f32 v160, v176, v177
    v_cvt_pk_bf16_f32 v161, v178, v179
    v_cvt_pk_bf16_f32 v162, v180, v181
    v_cvt_pk_bf16_f32 v163, v182, v183
    v_cvt_pk_bf16_f32 v164, v184, v185
    v_cvt_pk_bf16_f32 v165, v186, v187
    v_cvt_pk_bf16_f32 v166, v188, v189
    v_cvt_pk_bf16_f32 v167, v190, v191
    v_mov_b32 v40, v29
    s_nop 1
    v_permlane32_swap_b32 v29, v40
    s_nop 1
    v_add_f32 v29, v29, v40
    s_xor_b32 s95, s98, 8192
    s_add_u32 s95, s95, 16384
    v_lshlrev_b32 v40, 3, v1
    v_add_u32 v41, s95, v40
    ds_write_b64 v41, v[28:29]
    s_waitcnt lgkmcnt(0)
    s_barrier
    s_add_u32 s95, s98, 16384
    v_add_u32 v41, s95, v40
    ds_read_b64 v[44:45], v41
    s_waitcnt lgkmcnt(0)
    v_mfma_f32_32x32x16_bf16 v[64:79], v[200:203], v[160:163], v[64:79]
    v_max_f32 v40, v28, v44
    v_sub_f32 v41, v28, v40
    v_mfma_f32_32x32x16_bf16 v[80:95], v[204:207], v[160:163], v[80:95]
    v_sub_f32 v42, v44, v40
    v_exp_f32 v41, v41
    v_mfma_f32_32x32x16_bf16 v[96:111], v[208:211], v[160:163], v[96:111]
    v_exp_f32 v42, v42
    s_nop 0
    v_mfma_f32_32x32x16_bf16 v[112:127], v[212:215], v[160:163], v[112:127]
    v_mul_f32 v40, v29, v41
    v_fma_f32 v40, v45, v42, v40
    v_mfma_f32_32x32x16_bf16 v[64:79], v[216:219], v[164:167], v[64:79]
    v_rcp_f32 v40, v40
    s_nop 0
    v_mfma_f32_32x32x16_bf16 v[80:95], v[220:223], v[164:167], v[80:95]
    v_mul_f32 v31, v41, v40
    v_mfma_f32_32x32x16_bf16 v[96:111], v[224:227], v[164:167], v[96:111]
    v_mfma_f32_32x32x16_bf16 v[112:127], v[228:231], v[164:167], v[112:127]
    s_waitcnt vmcnt(4)
    s_mov_b32 s22, 0
L_tag_14:
    v_readfirstlane_b32 s18, v46
    v_readfirstlane_b32 s19, v47
    s_nop 3
    s_cmp_lg_u32 s18, 0
    s_cbranch_scc1 L_tagd_15
    v_mov_b32 v43, 0
    buffer_load_dwordx2 v[46:47], v43, s[76:79], 0 offen sc1
    s_waitcnt vmcnt(0)
    s_add_u32 s22, s22, 1
    s_cmp_lt_u32 s22, 0x100000
    s_cbranch_scc1 L_tag_14
L_tagd_15:
    s_xor_b32 s95, s98, 8192
    s_add_u32 s94, s98, 16384
    v_add_u32 v46, s94, v27
    s_add_u32 s94, s98, 32768
    v_add_u32 v47, s94, v27
    s_add_u32 s94, s95, 16384
    v_add_u32 v21, s94, v27
    s_add_u32 s94, s95, 32768
    v_add_u32 v26, s94, v27
    v_mul_f32 v64, v64, v31
    v_mul_f32 v65, v65, v31
    v_mul_f32 v66, v66, v31
    v_mul_f32 v67, v67, v31
    v_mul_f32 v68, v68, v31
    v_mul_f32 v69, v69, v31
    v_mul_f32 v70, v70, v31
    v_mul_f32 v71, v71, v31
    v_mul_f32 v72, v72, v31
    v_mul_f32 v73, v73, v31
    v_mul_f32 v74, v74, v31
    v_mul_f32 v75, v75, v31
    v_mul_f32 v76, v76, v31
    v_mul_f32 v77, v77, v31
    v_mul_f32 v78, v78, v31
    v_mul_f32 v79, v79, v31
    v_mul_f32 v80, v80, v31
    v_mul_f32 v81, v81, v31
    v_mul_f32 v82, v82, v31
    v_mul_f32 v83, v83, v31
    v_mul_f32 v84, v84, v31
    v_mul_f32 v85, v85, v31
    v_mul_f32 v86, v86, v31
    v_mul_f32 v87, v87, v31
    v_mul_f32 v88, v88, v31
    v_mul_f32 v89, v89, v31
    v_mul_f32 v90, v90, v31
    v_mul_f32 v91, v91, v31
    v_mul_f32 v92, v92, v31
    v_mul_f32 v93, v93, v31
    v_mul_f32 v94, v94, v31
    v_mul_f32 v95, v95, v31
    v_mul_f32 v96, v96, v31
    v_mul_f32 v97, v97, v31
    v_mul_f32 v98, v98, v31
    v_mul_f32 v99, v99, v31
    v_mul_f32 v100, v100, v31
    v_mul_f32 v101, v101, v31
    v_mul_f32 v102, v102, v31
    v_mul_f32 v103, v103, v31
    v_mul_f32 v104, v104, v31
    v_mul_f32 v105, v105, v31
    v_mul_f32 v106, v106, v31
    v_mul_f32 v107, v107, v31
    v_mul_f32 v108, v108, v31
    v_mul_f32 v109, v109, v31
    v_mul_f32 v110, v110, v31
    v_mul_f32 v111, v111, v31
    v_mul_f32 v112, v112, v31
    v_mul_f32 v113, v113, v31
    v_mul_f32 v114, v114, v31
    v_mul_f32 v115, v115, v31
    v_mul_f32 v116, v116, v31
    v_mul_f32 v117, v117, v31
    v_mul_f32 v118, v118, v31
    v_mul_f32 v119, v119, v31
    v_mul_f32 v120, v120, v31
    v_mul_f32 v121, v121, v31
    v_mul_f32 v122, v122, v31
    v_mul_f32 v123, v123, v31
    v_mul_f32 v124, v124, v31
    v_mul_f32 v125, v125, v31
    v_mul_f32 v126, v126, v31
    v_mul_f32 v127, v127, v31
    s_waitcnt vmcnt(0)
    s_call_b64 s[30:31], L_exch
    v_cvt_pk_bf16_f32 v128, v64, v65
    v_cvt_pk_bf16_f32 v129, v66, v67
    v_cvt_pk_bf16_f32 v130, v68, v69
    v_cvt_pk_bf16_f32 v131, v70, v71
    v_cvt_pk_bf16_f32 v132, v72, v73
    v_cvt_pk_bf16_f32 v133, v74, v75
    v_cvt_pk_bf16_f32 v134, v76, v77
    v_cvt_pk_bf16_f32 v135, v78, v79
    v_cvt_pk_bf16_f32 v136, v80, v81
    v_cvt_pk_bf16_f32 v137, v82, v83
    v_cvt_pk_bf16_f32 v138, v84, v85
    v_cvt_pk_bf16_f32 v139, v86, v87
    v_cvt_pk_bf16_f32 v140, v88, v89
    v_cvt_pk_bf16_f32 v141, v90, v91
    v_cvt_pk_bf16_f32 v142, v92, v93
    v_cvt_pk_bf16_f32 v143, v94, v95
    s_lshl_b32 s95, s86, 12
    s_add_u32 s87, s23, s95
    v_permlane32_swap_b32 v128, v130
    v_permlane32_swap_b32 v129, v131
    v_permlane32_swap_b32 v132, v134
    v_permlane32_swap_b32 v133, v135
    v_permlane32_swap_b32 v136, v138
    v_permlane32_swap_b32 v137, v139
    v_permlane32_swap_b32 v140, v142
    v_permlane32_swap_b32 v141, v143
    s_lshl_b32 s94, s81, 17
    s_add_u32 s94, s94, s87
    buffer_store_dwordx4 v[128:131], v27, s[52:55], s94 offen offset:0 sc1
    buffer_store_dwordx4 v[132:135], v27, s[52:55], s94 offen offset:1024 sc1
    buffer_store_dwordx4 v[136:139], v27, s[52:55], s94 offen offset:2048 sc1
    buffer_store_dwordx4 v[140:143], v27, s[52:55], s94 offen offset:3072 sc1
    s_barrier
    v_add_u32 v40, s98, v27
    ds_write_b128 v40, v[48:51] offset:16384
    ds_write_b128 v40, v[52:55] offset:17408
    ds_write_b128 v40, v[56:59] offset:18432
    ds_write_b128 v40, v[60:63] offset:19456
    v_mov_b32 v64, 0
    v_mov_b32 v65, 0
    v_mov_b32 v66, 0
    v_mov_b32 v67, 0
    v_mov_b32 v68, 0
    v_mov_b32 v69, 0
    v_mov_b32 v70, 0
    v_mov_b32 v71, 0
    v_mov_b32 v72, 0
    v_mov_b32 v73, 0
    v_mov_b32 v74, 0
    v_mov_b32 v75, 0
    v_mov_b32 v76, 0
    v_mov_b32 v77, 0
    v_mov_b32 v78, 0
    v_mov_b32 v79, 0
    v_mov_b32 v80, 0
    v_mov_b32 v81, 0
    v_mov_b32 v82, 0
    v_mov_b32 v83, 0
    v_mov_b32 v84, 0
    v_mov_b32 v85, 0
    v_mov_b32 v86, 0
    v_mov_b32 v87, 0
    v_mov_b32 v88, 0
    v_mov_b32 v89, 0
    v_mov_b32 v90, 0
    v_mov_b32 v91, 0
    v_mov_b32 v92, 0
    v_mov_b32 v93, 0
    v_mov_b32 v94, 0
    v_mov_b32 v95, 0
    v_mov_b32 v96, 0
    v_mov_b32 v97, 0
    v_mov_b32 v98, 0
    v_mov_b32 v99, 0
    v_mov_b32 v100, 0
    v_mov_b32 v101, 0
    v_mov_b32 v102, 0
    v_mov_b32 v103, 0
    v_mov_b32 v104, 0
    v_mov_b32 v105, 0
    v_mov_b32 v106, 0
    v_mov_b32 v107, 0
    v_mov_b32 v108, 0
    v_mov_b32 v109, 0
    v_mov_b32 v110, 0
    v_mov_b32 v111, 0
    v_mov_b32 v112, 0
    v_mov_b32 v113, 0
    v_mov_b32 v114, 0
    v_mov_b32 v115, 0
    v_mov_b32 v116, 0
    v_mov_b32 v117, 0
    v_mov_b32 v118, 0
    v_mov_b32 v119, 0
    v_mov_b32 v120, 0
    v_mov_b32 v121, 0
    v_mov_b32 v122, 0
    v_mov_b32 v123, 0
    v_mov_b32 v124, 0
    v_mov_b32 v125, 0
    v_mov_b32 v126, 0
    v_mov_b32 v127, 0
    s_lshr_b32 s90, s100, 5
    s_lshl_b32 s90, s90, 3
    s_add_u32 s90, s90, s80
    s_lshl_b32 s90, s90, 11
    s_lshl_b32 s95, s84, 7
    s_add_u32 s90, s90, s95
    v_add_u32 v21, s81, v1
    v_and_b32 v21, 3, v21
    v_lshlrev_b32 v21, 9, v21
    v_mov_b32 v46, s18
    v_mov_b32 v47, s19
    s_mul_i32 s94, s86, 81920
    s_add_u32 s8, s94, 49152
    s_add_u32 s9, s94, 65536
    s_add_u32 s10, s94, 0
    s_add_u32 s11, s94, 16384
    s_waitcnt vmcnt(0)
    s_mov_b64 exec, 1
    buffer_store_dwordx2 v[46:47], v21, s[64:67], s90 offen sc1
    s_mov_b64 exec, -1
    s_call_b64 s[30:31], L_wS0
    s_waitcnt lgkmcnt(0)
    s_barrier
    s_mov_b32 s89, 1
    s_mov_b32 s88, 1
    s_mov_b32 s22, 0
L_sib:
    s_mov_b64 exec, 15
    buffer_load_dwordx2 v[44:45], v21, s[64:67], s90 offen sc1
    s_waitcnt vmcnt(0)
    v_cmp_eq_u32 vcc, s18, v44
    v_cmp_eq_u32 s[96:97], s19, v45
    s_mov_b64 exec, -1
    s_add_u32 s22, s22, 1
    s_and_b32 s96, vcc_lo, s96
    s_cmp_lt_u32 s22, 0x100000
    s_cselect_b32 s96, s96, 15
    s_andn2_b32 s96, s96, s89
    s_cbranch_scc0 L_sib
    s_or_b32 s89, s89, s96
    s_bitcmp0_b32 s96, 1
    s_cbranch_scc1 L_ld_16
    s_add_u32 s94, s81, 1
    s_and_b32 s94, s94, 3
    s_lshl_b32 s94, s94, 17
    s_add_u32 s94, s94, s87
    buffer_load_dwordx4 v[144:147], v27, s[52:55], s94 offen offset:0 sc1
    buffer_load_dwordx4 v[148:151], v27, s[52:55], s94 offen offset:1024 sc1
    buffer_load_dwordx4 v[152:155], v27, s[52:55], s94 offen offset:2048 sc1
    buffer_load_dwordx4 v[156:159], v27, s[52:55], s94 offen offset:3072 sc1
L_ld_16:
    s_bitcmp0_b32 s96, 2
    s_cbranch_scc1 L_ld_17
    s_add_u32 s94, s81, 2
    s_and_b32 s94, s94, 3
    s_lshl_b32 s94, s94, 17
    s_add_u32 s94, s94, s87
    buffer_load_dwordx4 v[160:163], v27, s[52:55], s94 offen offset:0 sc1
    buffer_load_dwordx4 v[164:167], v27, s[52:55], s94 offen offset:1024 sc1
    buffer_load_dwordx4 v[168:171], v27, s[52:55], s94 offen offset:2048 sc1
    buffer_load_dwordx4 v[172:175], v27, s[52:55], s94 offen offset:3072 sc1
L_ld_17:
    s_bitcmp0_b32 s96, 3
    s_cbranch_scc1 L_ld_18
    s_add_u32 s94, s81, 3
    s_and_b32 s94, s94, 3
    s_lshl_b32 s94, s94, 17
    s_add_u32 s94, s94, s87
    buffer_load_dwordx4 v[176:179], v27, s[52:55], s94 offen offset:0 sc1
    buffer_load_dwordx4 v[180:183], v27, s[52:55], s94 offen offset:1024 sc1
    buffer_load_dwordx4 v[184:187], v27, s[52:55], s94 offen offset:2048 sc1
    buffer_load_dwordx4 v[188:191], v27, s[52:55], s94 offen offset:3072 sc1
L_ld_18:
    s_mov_b32 s91, s96
    s_waitcnt vmcnt(0)
    s_bitcmp0_b32 s91, 1
    s_cbranch_scc1 L_st_19
    s_call_b64 s[30:31], L_wS1
L_st_19:
    s_bitcmp0_b32 s91, 2
    s_cbranch_scc1 L_st_20
    s_call_b64 s[30:31], L_wS2
L_st_20:
    s_bitcmp0_b32 s91, 3
    s_cbranch_scc1 L_st_21
    s_call_b64 s[30:31], L_wS3
L_st_21:
    s_cmp_lg_u32 s89, 15
    s_cbranch_scc1 L_sib
    s_xor_b32 s95, s98, 8192
    s_add_u32 s94, s98, 49152
    v_add_u32 v46, s94, v27
    s_add_u32 s94, s98, 32768
    v_add_u32 v47, s94, v27
    s_add_u32 s94, s95, 49152
    v_add_u32 v21, s94, v27
    s_add_u32 s94, s95, 32768
    v_add_u32 v26, s94, v27
    s_nop 7
    s_call_b64 s[30:31], L_exch
    v_cvt_pk_bf16_f32 v200, v64, v65
    v_cvt_pk_bf16_f32 v201, v66, v67
    v_cvt_pk_bf16_f32 v202, v68, v69
    v_cvt_pk_bf16_f32 v203, v70, v71
    v_cvt_pk_bf16_f32 v204, v72, v73
    v_cvt_pk_bf16_f32 v205, v74, v75
    v_cvt_pk_bf16_f32 v206, v76, v77
    v_cvt_pk_bf16_f32 v207, v78, v79
    v_cvt_pk_bf16_f32 v208, v80, v81
    v_cvt_pk_bf16_f32 v209, v82, v83
    v_cvt_pk_bf16_f32 v210, v84, v85
    v_cvt_pk_bf16_f32 v211, v86, v87
    v_cvt_pk_bf16_f32 v212, v88, v89
    v_cvt_pk_bf16_f32 v213, v90, v91
    v_cvt_pk_bf16_f32 v214, v92, v93
    v_cvt_pk_bf16_f32 v215, v94, v95
    s_lshl_b32 s94, s80, 14
    s_lshl_b32 s95, s86, 13
    s_add_u32 s94, s94, s95
    s_lshl_b32 s95, s85, 11
    s_add_u32 s94, s94, s95
    s_add_u32 s95, s94, 4096
    buffer_store_dwordx4 v[200:203], v27, s[56:59], s94 offen offset:0 sc1
    buffer_store_dwordx4 v[204:207], v27, s[56:59], s94 offen offset:1024 sc1
    buffer_store_dwordx4 v[208:211], v27, s[56:59], s95 offen offset:0 sc1
    buffer_store_dwordx4 v[212:215], v27, s[56:59], s95 offen offset:1024 sc1
    s_lshr_b32 s91, s100, 3
    s_lshl_b32 s91, s91, 12
    s_add_u32 s91, s91, 262144
    s_lshl_b32 s94, s80, 9
    s_lshl_b32 s95, s84, 7
    s_add_u32 s94, s94, s95
    s_add_u32 s89, s91, s94
    s_and_b32 s94, s80, 1
    s_lshr_b32 s95, s80, 2
    s_lshl_b32 s95, s95, 1
    s_add_u32 s94, s94, s95
    s_lshl_b32 s94, s94, 7
    s_add_u32 s91, s91, s94
    s_mov_b32 s60, s24
    s_mov_b32 s61, s25
    s_mov_b32 s62, 0x100000
    s_mov_b32 s63, 0x00020000
    v_mov_b32 v44, s18
    v_mov_b32 v45, s19
    v_mov_b32 v40, 0
    s_waitcnt vmcnt(0)
    s_mov_b64 exec, 1
    buffer_store_dwordx2 v[44:45], v40, s[64:67], s89 offen sc1
    s_mov_b64 exec, -1
    s_cmp_ge_u32 s84, 2
    s_cbranch_scc1 L_end
    v_lshlrev_b32 v40, 9, v1
    s_mov_b32 s22, 0
    s_mov_b64 exec, 0xff
L_poll_22:
    buffer_load_dwordx2 v[44:45], v40, s[64:67], s91 offen sc1
    s_waitcnt vmcnt(0)
    v_cmp_eq_u32 vcc, s18, v44
    v_cmp_eq_u32 s[96:97], s19, v45
    s_nop 1
    s_and_b64 vcc, vcc, s[96:97]
    s_cmp_eq_u32 vcc_lo, 0xff
    s_cbranch_scc1 L_polld_23
    s_sleep 1
    s_add_u32 s22, s22, 1
    s_cmp_lt_u32 s22, 0x100000
    s_cbranch_scc1 L_poll_22
L_polld_23:
    s_mov_b64 exec, -1
    s_lshl_b32 s94, s80, 11
    s_lshl_b32 s95, s84, 10
    s_add_u32 s94, s94, s95
    buffer_load_dwordx4 v[200:203], v27, s[56:59], s94 offen sc1
    s_add_u32 s94, s94, 16384
    buffer_load_dwordx4 v[204:207], v27, s[56:59], s94 offen sc1
    s_add_u32 s94, s94, 16384
    buffer_load_dwordx4 v[208:211], v27, s[56:59], s94 offen sc1
    s_add_u32 s94, s94, 16384
    buffer_load_dwordx4 v[212:215], v27, s[56:59], s94 offen sc1
    s_add_u32 s94, s94, 16384
    buffer_load_dwordx4 v[216:219], v27, s[56:59], s94 offen sc1
    s_add_u32 s94, s94, 16384
    buffer_load_dwordx4 v[220:223], v27, s[56:59], s94 offen sc1
    s_add_u32 s94, s94, 16384
    buffer_load_dwordx4 v[224:227], v27, s[56:59], s94 offen sc1
    s_add_u32 s94, s94, 16384
    buffer_load_dwordx4 v[228:231], v27, s[56:59], s94 offen sc1
    s_add_u32 s94, s94, 16384
    s_lshl_b32 s94, s83, 6
    s_and_b32 s95, s80, 1
    s_lshl_b32 s95, s95, 5
    s_add_u32 s94, s94, s95
    s_lshl_b32 s94, s94, 11
    s_lshl_b32 s95, s82, 10
    s_add_u32 s94, s94, s95
    s_lshl_b32 s95, s81, 8
    s_add_u32 s94, s94, s95
    s_lshr_b32 s95, s80, 1
    s_lshl_b32 s95, s95, 6
    s_add_u32 s94, s94, s95
    s_lshl_b32 s95, s84, 5
    s_add_u32 s94, s94, s95
    v_and_b32 v40, 31, v1
    v_lshlrev_b32 v40, 11, v40
    v_lshrrev_b32 v41, 5, v1
    v_lshl_add_u32 v40, v41, 3, v40
    s_waitcnt vmcnt(7)
    v_lshlrev_b32 v64, 16, v200
    v_and_b32 v65, 0xffff0000, v200
    v_lshlrev_b32 v66, 16, v201
    v_and_b32 v67, 0xffff0000, v201
    v_lshlrev_b32 v68, 16, v202
    v_and_b32 v69, 0xffff0000, v202
    v_lshlrev_b32 v70, 16, v203
    v_and_b32 v71, 0xffff0000, v203
    s_waitcnt vmcnt(6)
    v_lshlrev_b32 v72, 16, v204
    v_and_b32 v73, 0xffff0000, v204
    v_add_f32 v64, v64, v72
    v_add_f32 v65, v65, v73
    v_lshlrev_b32 v72, 16, v205
    v_and_b32 v73, 0xffff0000, v205
    v_add_f32 v66, v66, v72
    v_add_f32 v67, v67, v73
    v_lshlrev_b32 v72, 16, v206
    v_and_b32 v73, 0xffff0000, v206
    v_add_f32 v68, v68, v72
    v_add_f32 v69, v69, v73
    v_lshlrev_b32 v72, 16, v207
    v_and_b32 v73, 0xffff0000, v207
    v_add_f32 v70, v70, v72
    v_add_f32 v71, v71, v73
    s_waitcnt vmcnt(5)
    v_lshlrev_b32 v72, 16, v208
    v_and_b32 v73, 0xffff0000, v208
    v_add_f32 v64, v64, v72
    v_add_f32 v65, v65, v73
    v_lshlrev_b32 v72, 16, v209
    v_and_b32 v73, 0xffff0000, v209
    v_add_f32 v66, v66, v72
    v_add_f32 v67, v67, v73
    v_lshlrev_b32 v72, 16, v210
    v_and_b32 v73, 0xffff0000, v210
    v_add_f32 v68, v68, v72
    v_add_f32 v69, v69, v73
    v_lshlrev_b32 v72, 16, v211
    v_and_b32 v73, 0xffff0000, v211
    v_add_f32 v70, v70, v72
    v_add_f32 v71, v71, v73
    s_waitcnt vmcnt(4)
    v_lshlrev_b32 v72, 16, v212
    v_and_b32 v73, 0xffff0000, v212
    v_add_f32 v64, v64, v72
    v_add_f32 v65, v65, v73
    v_lshlrev_b32 v72, 16, v213
    v_and_b32 v73, 0xffff0000, v213
    v_add_f32 v66, v66, v72
    v_add_f32 v67, v67, v73
    v_lshlrev_b32 v72, 16, v214
    v_and_b32 v73, 0xffff0000, v214
    v_add_f32 v68, v68, v72
    v_add_f32 v69, v69, v73
    v_lshlrev_b32 v72, 16, v215
    v_and_b32 v73, 0xffff0000, v215
    v_add_f32 v70, v70, v72
    v_add_f32 v71, v71, v73
    s_waitcnt vmcnt(3)
    v_lshlrev_b32 v72, 16, v216
    v_and_b32 v73, 0xffff0000, v216
    v_add_f32 v64, v64, v72
    v_add_f32 v65, v65, v73
    v_lshlrev_b32 v72, 16, v217
    v_and_b32 v73, 0xffff0000, v217
    v_add_f32 v66, v66, v72
    v_add_f32 v67, v67, v73
    v_lshlrev_b32 v72, 16, v218
    v_and_b32 v73, 0xffff0000, v218
    v_add_f32 v68, v68, v72
    v_add_f32 v69, v69, v73
    v_lshlrev_b32 v72, 16, v219
    v_and_b32 v73, 0xffff0000, v219
    v_add_f32 v70, v70, v72
    v_add_f32 v71, v71, v73
    s_waitcnt vmcnt(2)
    v_lshlrev_b32 v72, 16, v220
    v_and_b32 v73, 0xffff0000, v220
    v_add_f32 v64, v64, v72
    v_add_f32 v65, v65, v73
    v_lshlrev_b32 v72, 16, v221
    v_and_b32 v73, 0xffff0000, v221
    v_add_f32 v66, v66, v72
    v_add_f32 v67, v67, v73
    v_lshlrev_b32 v72, 16, v222
    v_and_b32 v73, 0xffff0000, v222
    v_add_f32 v68, v68, v72
    v_add_f32 v69, v69, v73
    v_lshlrev_b32 v72, 16, v223
    v_and_b32 v73, 0xffff0000, v223
    v_add_f32 v70, v70, v72
    v_add_f32 v71, v71, v73
    s_waitcnt vmcnt(1)
    v_lshlrev_b32 v72, 16, v224
    v_and_b32 v73, 0xffff0000, v224
    v_add_f32 v64, v64, v72
    v_add_f32 v65, v65, v73
    v_lshlrev_b32 v72, 16, v225
    v_and_b32 v73, 0xffff0000, v225
    v_add_f32 v66, v66, v72
    v_add_f32 v67, v67, v73
    v_lshlrev_b32 v72, 16, v226
    v_and_b32 v73, 0xffff0000, v226
    v_add_f32 v68, v68, v72
    v_add_f32 v69, v69, v73
    v_lshlrev_b32 v72, 16, v227
    v_and_b32 v73, 0xffff0000, v227
    v_add_f32 v70, v70, v72
    v_add_f32 v71, v71, v73
    s_waitcnt vmcnt(0)
    v_lshlrev_b32 v72, 16, v228
    v_and_b32 v73, 0xffff0000, v228
    v_add_f32 v64, v64, v72
    v_add_f32 v65, v65, v73
    v_lshlrev_b32 v72, 16, v229
    v_and_b32 v73, 0xffff0000, v229
    v_add_f32 v66, v66, v72
    v_add_f32 v67, v67, v73
    v_lshlrev_b32 v72, 16, v230
    v_and_b32 v73, 0xffff0000, v230
    v_add_f32 v68, v68, v72
    v_add_f32 v69, v69, v73
    v_lshlrev_b32 v72, 16, v231
    v_and_b32 v73, 0xffff0000, v231
    v_add_f32 v70, v70, v72
    v_add_f32 v71, v71, v73
    v_cvt_pk_bf16_f32 v76, v64, v65
    v_cvt_pk_bf16_f32 v77, v66, v67
    v_cvt_pk_bf16_f32 v78, v68, v69
    v_cvt_pk_bf16_f32 v79, v70, v71
    buffer_store_dwordx2 v[76:77], v40, s[60:63], s94 offen
    buffer_store_dwordx2 v[78:79], v40, s[60:63], s94 offen offset:16
L_end:
    s_endpgm
L_wS0:
    v_add_u32 v32, s8, v25
    v_xor_b32 v33, 16, v32
    v_xor_b32 v34, 64, v32
    v_xor_b32 v35, 80, v32
    v_xor_b32 v36, 128, v32
    v_xor_b32 v37, 144, v32
    v_xor_b32 v38, 192, v32
    v_xor_b32 v39, 208, v32
    ds_read_b64_tr_b16 v[192:193], v32 offset:0
    ds_read_b64_tr_b16 v[194:195], v33 offset:1024
    ds_read_b64_tr_b16 v[196:197], v34 offset:0
    ds_read_b64_tr_b16 v[198:199], v35 offset:1024
    ds_read_b64_tr_b16 v[200:201], v36 offset:0
    ds_read_b64_tr_b16 v[202:203], v37 offset:1024
    ds_read_b64_tr_b16 v[204:205], v38 offset:0
    ds_read_b64_tr_b16 v[206:207], v39 offset:1024
    ds_read_b64_tr_b16 v[208:209], v32 offset:4096
    ds_read_b64_tr_b16 v[210:211], v33 offset:5120
    ds_read_b64_tr_b16 v[212:213], v34 offset:4096
    ds_read_b64_tr_b16 v[214:215], v35 offset:5120
    s_waitcnt lgkmcnt(8)
    v_mfma_f32_32x32x16_bf16 v[64:79], v[192:195], v[128:131], v[64:79]
    ds_read_b64_tr_b16 v[216:217], v36 offset:4096
    ds_read_b64_tr_b16 v[218:219], v37 offset:5120
    v_mfma_f32_32x32x16_bf16 v[80:95], v[196:199], v[128:131], v[80:95]
    ds_read_b64_tr_b16 v[220:221], v38 offset:4096
    ds_read_b64_tr_b16 v[222:223], v39 offset:5120
    s_waitcnt lgkmcnt(8)
    v_mfma_f32_32x32x16_bf16 v[96:111], v[200:203], v[128:131], v[96:111]
    ds_read_b64_tr_b16 v[192:193], v32 offset:8192
    ds_read_b64_tr_b16 v[194:195], v33 offset:9216
    v_mfma_f32_32x32x16_bf16 v[112:127], v[204:207], v[128:131], v[112:127]
    ds_read_b64_tr_b16 v[196:197], v34 offset:8192
    ds_read_b64_tr_b16 v[198:199], v35 offset:9216
    s_waitcnt lgkmcnt(8)
    v_mfma_f32_32x32x16_bf16 v[64:79], v[208:211], v[132:135], v[64:79]
    ds_read_b64_tr_b16 v[200:201], v36 offset:8192
    ds_read_b64_tr_b16 v[202:203], v37 offset:9216
    v_mfma_f32_32x32x16_bf16 v[80:95], v[212:215], v[132:135], v[80:95]
    ds_read_b64_tr_b16 v[204:205], v38 offset:8192
    ds_read_b64_tr_b16 v[206:207], v39 offset:9216
    s_waitcnt lgkmcnt(8)
    v_mfma_f32_32x32x16_bf16 v[96:111], v[216:219], v[132:135], v[96:111]
    ds_read_b64_tr_b16 v[208:209], v32 offset:12288
    ds_read_b64_tr_b16 v[210:211], v33 offset:13312
    v_mfma_f32_32x32x16_bf16 v[112:127], v[220:223], v[132:135], v[112:127]
    ds_read_b64_tr_b16 v[212:213], v34 offset:12288
    ds_read_b64_tr_b16 v[214:215], v35 offset:13312
    s_waitcnt lgkmcnt(8)
    v_mfma_f32_32x32x16_bf16 v[64:79], v[192:195], v[136:139], v[64:79]
    ds_read_b64_tr_b16 v[216:217], v36 offset:12288
    ds_read_b64_tr_b16 v[218:219], v37 offset:13312
    v_mfma_f32_32x32x16_bf16 v[80:95], v[196:199], v[136:139], v[80:95]
    ds_read_b64_tr_b16 v[220:221], v38 offset:12288
    ds_read_b64_tr_b16 v[222:223], v39 offset:13312
    s_waitcnt lgkmcnt(8)
    v_mfma_f32_32x32x16_bf16 v[96:111], v[200:203], v[136:139], v[96:111]
    v_mfma_f32_32x32x16_bf16 v[112:127], v[204:207], v[136:139], v[112:127]
    s_waitcnt lgkmcnt(4)
    v_mfma_f32_32x32x16_bf16 v[64:79], v[208:211], v[140:143], v[64:79]
    v_mfma_f32_32x32x16_bf16 v[80:95], v[212:215], v[140:143], v[80:95]
    s_waitcnt lgkmcnt(0)
    v_mfma_f32_32x32x16_bf16 v[96:111], v[216:219], v[140:143], v[96:111]
    v_mfma_f32_32x32x16_bf16 v[112:127], v[220:223], v[140:143], v[112:127]
    s_setpc_b64 s[30:31]
L_wS1:
    v_add_u32 v32, s9, v25
    v_xor_b32 v33, 16, v32
    v_xor_b32 v34, 64, v32
    v_xor_b32 v35, 80, v32
    v_xor_b32 v36, 128, v32
    v_xor_b32 v37, 144, v32
    v_xor_b32 v38, 192, v32
    v_xor_b32 v39, 208, v32
    ds_read_b64_tr_b16 v[192:193], v32 offset:0
    ds_read_b64_tr_b16 v[194:195], v33 offset:1024
    ds_read_b64_tr_b16 v[196:197], v34 offset:0
    ds_read_b64_tr_b16 v[198:199], v35 offset:1024
    ds_read_b64_tr_b16 v[200:201], v36 offset:0
    ds_read_b64_tr_b16 v[202:203], v37 offset:1024
    ds_read_b64_tr_b16 v[204:205], v38 offset:0
    ds_read_b64_tr_b16 v[206:207], v39 offset:1024
    ds_read_b64_tr_b16 v[208:209], v32 offset:4096
    ds_read_b64_tr_b16 v[210:211], v33 offset:5120
    ds_read_b64_tr_b16 v[212:213], v34 offset:4096
    ds_read_b64_tr_b16 v[214:215], v35 offset:5120
    s_waitcnt lgkmcnt(8)
    v_mfma_f32_32x32x16_bf16 v[64:79], v[192:195], v[144:147], v[64:79]
    ds_read_b64_tr_b16 v[216:217], v36 offset:4096
    ds_read_b64_tr_b16 v[218:219], v37 offset:5120
    v_mfma_f32_32x32x16_bf16 v[80:95], v[196:199], v[144:147], v[80:95]
    ds_read_b64_tr_b16 v[220:221], v38 offset:4096
    ds_read_b64_tr_b16 v[222:223], v39 offset:5120
    s_waitcnt lgkmcnt(8)
    v_mfma_f32_32x32x16_bf16 v[96:111], v[200:203], v[144:147], v[96:111]
    ds_read_b64_tr_b16 v[192:193], v32 offset:8192
    ds_read_b64_tr_b16 v[194:195], v33 offset:9216
    v_mfma_f32_32x32x16_bf16 v[112:127], v[204:207], v[144:147], v[112:127]
    ds_read_b64_tr_b16 v[196:197], v34 offset:8192
    ds_read_b64_tr_b16 v[198:199], v35 offset:9216
    s_waitcnt lgkmcnt(8)
    v_mfma_f32_32x32x16_bf16 v[64:79], v[208:211], v[148:151], v[64:79]
    ds_read_b64_tr_b16 v[200:201], v36 offset:8192
    ds_read_b64_tr_b16 v[202:203], v37 offset:9216
    v_mfma_f32_32x32x16_bf16 v[80:95], v[212:215], v[148:151], v[80:95]
    ds_read_b64_tr_b16 v[204:205], v38 offset:8192
    ds_read_b64_tr_b16 v[206:207], v39 offset:9216
    s_waitcnt lgkmcnt(8)
    v_mfma_f32_32x32x16_bf16 v[96:111], v[216:219], v[148:151], v[96:111]
    ds_read_b64_tr_b16 v[208:209], v32 offset:12288
    ds_read_b64_tr_b16 v[210:211], v33 offset:13312
    v_mfma_f32_32x32x16_bf16 v[112:127], v[220:223], v[148:151], v[112:127]
    ds_read_b64_tr_b16 v[212:213], v34 offset:12288
    ds_read_b64_tr_b16 v[214:215], v35 offset:13312
    s_waitcnt lgkmcnt(8)
    v_mfma_f32_32x32x16_bf16 v[64:79], v[192:195], v[152:155], v[64:79]
    ds_read_b64_tr_b16 v[216:217], v36 offset:12288
    ds_read_b64_tr_b16 v[218:219], v37 offset:13312
    v_mfma_f32_32x32x16_bf16 v[80:95], v[196:199], v[152:155], v[80:95]
    ds_read_b64_tr_b16 v[220:221], v38 offset:12288
    ds_read_b64_tr_b16 v[222:223], v39 offset:13312
    s_waitcnt lgkmcnt(8)
    v_mfma_f32_32x32x16_bf16 v[96:111], v[200:203], v[152:155], v[96:111]
    v_mfma_f32_32x32x16_bf16 v[112:127], v[204:207], v[152:155], v[112:127]
    s_waitcnt lgkmcnt(4)
    v_mfma_f32_32x32x16_bf16 v[64:79], v[208:211], v[156:159], v[64:79]
    v_mfma_f32_32x32x16_bf16 v[80:95], v[212:215], v[156:159], v[80:95]
    s_waitcnt lgkmcnt(0)
    v_mfma_f32_32x32x16_bf16 v[96:111], v[216:219], v[156:159], v[96:111]
    v_mfma_f32_32x32x16_bf16 v[112:127], v[220:223], v[156:159], v[112:127]
    s_setpc_b64 s[30:31]
L_wS2:
    v_add_u32 v32, s10, v25
    v_xor_b32 v33, 16, v32
    v_xor_b32 v34, 64, v32
    v_xor_b32 v35, 80, v32
    v_xor_b32 v36, 128, v32
    v_xor_b32 v37, 144, v32
    v_xor_b32 v38, 192, v32
    v_xor_b32 v39, 208, v32
    ds_read_b64_tr_b16 v[192:193], v32 offset:0
    ds_read_b64_tr_b16 v[194:195], v33 offset:1024
    ds_read_b64_tr_b16 v[196:197], v34 offset:0
    ds_read_b64_tr_b16 v[198:199], v35 offset:1024
    ds_read_b64_tr_b16 v[200:201], v36 offset:0
    ds_read_b64_tr_b16 v[202:203], v37 offset:1024
    ds_read_b64_tr_b16 v[204:205], v38 offset:0
    ds_read_b64_tr_b16 v[206:207], v39 offset:1024
    ds_read_b64_tr_b16 v[208:209], v32 offset:4096
    ds_read_b64_tr_b16 v[210:211], v33 offset:5120
    ds_read_b64_tr_b16 v[212:213], v34 offset:4096
    ds_read_b64_tr_b16 v[214:215], v35 offset:5120
    s_waitcnt lgkmcnt(8)
    v_mfma_f32_32x32x16_bf16 v[64:79], v[192:195], v[160:163], v[64:79]
    ds_read_b64_tr_b16 v[216:217], v36 offset:4096
    ds_read_b64_tr_b16 v[218:219], v37 offset:5120
    v_mfma_f32_32x32x16_bf16 v[80:95], v[196:199], v[160:163], v[80:95]
    ds_read_b64_tr_b16 v[220:221], v38 offset:4096
    ds_read_b64_tr_b16 v[222:223], v39 offset:5120
    s_waitcnt lgkmcnt(8)
    v_mfma_f32_32x32x16_bf16 v[96:111], v[200:203], v[160:163], v[96:111]
    ds_read_b64_tr_b16 v[192:193], v32 offset:8192
    ds_read_b64_tr_b16 v[194:195], v33 offset:9216
    v_mfma_f32_32x32x16_bf16 v[112:127], v[204:207], v[160:163], v[112:127]
    ds_read_b64_tr_b16 v[196:197], v34 offset:8192
    ds_read_b64_tr_b16 v[198:199], v35 offset:9216
    s_waitcnt lgkmcnt(8)
    v_mfma_f32_32x32x16_bf16 v[64:79], v[208:211], v[164:167], v[64:79]
    ds_read_b64_tr_b16 v[200:201], v36 offset:8192
    ds_read_b64_tr_b16 v[202:203], v37 offset:9216
    v_mfma_f32_32x32x16_bf16 v[80:95], v[212:215], v[164:167], v[80:95]
    ds_read_b64_tr_b16 v[204:205], v38 offset:8192
    ds_read_b64_tr_b16 v[206:207], v39 offset:9216
    s_waitcnt lgkmcnt(8)
    v_mfma_f32_32x32x16_bf16 v[96:111], v[216:219], v[164:167], v[96:111]
    ds_read_b64_tr_b16 v[208:209], v32 offset:12288
    ds_read_b64_tr_b16 v[210:211], v33 offset:13312
    v_mfma_f32_32x32x16_bf16 v[112:127], v[220:223], v[164:167], v[112:127]
    ds_read_b64_tr_b16 v[212:213], v34 offset:12288
    ds_read_b64_tr_b16 v[214:215], v35 offset:13312
    s_waitcnt lgkmcnt(8)
    v_mfma_f32_32x32x16_bf16 v[64:79], v[192:195], v[168:171], v[64:79]
    ds_read_b64_tr_b16 v[216:217], v36 offset:12288
    ds_read_b64_tr_b16 v[218:219], v37 offset:13312
    v_mfma_f32_32x32x16_bf16 v[80:95], v[196:199], v[168:171], v[80:95]
    ds_read_b64_tr_b16 v[220:221], v38 offset:12288
    ds_read_b64_tr_b16 v[222:223], v39 offset:13312
    s_waitcnt lgkmcnt(8)
    v_mfma_f32_32x32x16_bf16 v[96:111], v[200:203], v[168:171], v[96:111]
    v_mfma_f32_32x32x16_bf16 v[112:127], v[204:207], v[168:171], v[112:127]
    s_waitcnt lgkmcnt(4)
    v_mfma_f32_32x32x16_bf16 v[64:79], v[208:211], v[172:175], v[64:79]
    v_mfma_f32_32x32x16_bf16 v[80:95], v[212:215], v[172:175], v[80:95]
    s_waitcnt lgkmcnt(0)
    v_mfma_f32_32x32x16_bf16 v[96:111], v[216:219], v[172:175], v[96:111]
    v_mfma_f32_32x32x16_bf16 v[112:127], v[220:223], v[172:175], v[112:127]
    s_setpc_b64 s[30:31]
L_wS3:
    v_add_u32 v32, s11, v25
    v_xor_b32 v33, 16, v32
    v_xor_b32 v34, 64, v32
    v_xor_b32 v35, 80, v32
    v_xor_b32 v36, 128, v32
    v_xor_b32 v37, 144, v32
    v_xor_b32 v38, 192, v32
    v_xor_b32 v39, 208, v32
    ds_read_b64_tr_b16 v[192:193], v32 offset:0
    ds_read_b64_tr_b16 v[194:195], v33 offset:1024
    ds_read_b64_tr_b16 v[196:197], v34 offset:0
    ds_read_b64_tr_b16 v[198:199], v35 offset:1024
    ds_read_b64_tr_b16 v[200:201], v36 offset:0
    ds_read_b64_tr_b16 v[202:203], v37 offset:1024
    ds_read_b64_tr_b16 v[204:205], v38 offset:0
    ds_read_b64_tr_b16 v[206:207], v39 offset:1024
    ds_read_b64_tr_b16 v[208:209], v32 offset:4096
    ds_read_b64_tr_b16 v[210:211], v33 offset:5120
    ds_read_b64_tr_b16 v[212:213], v34 offset:4096
    ds_read_b64_tr_b16 v[214:215], v35 offset:5120
    s_waitcnt lgkmcnt(8)
    v_mfma_f32_32x32x16_bf16 v[64:79], v[192:195], v[176:179], v[64:79]
    ds_read_b64_tr_b16 v[216:217], v36 offset:4096
    ds_read_b64_tr_b16 v[218:219], v37 offset:5120
    v_mfma_f32_32x32x16_bf16 v[80:95], v[196:199], v[176:179], v[80:95]
    ds_read_b64_tr_b16 v[220:221], v38 offset:4096
    ds_read_b64_tr_b16 v[222:223], v39 offset:5120
    s_waitcnt lgkmcnt(8)
    v_mfma_f32_32x32x16_bf16 v[96:111], v[200:203], v[176:179], v[96:111]
    ds_read_b64_tr_b16 v[192:193], v32 offset:8192
    ds_read_b64_tr_b16 v[194:195], v33 offset:9216
    v_mfma_f32_32x32x16_bf16 v[112:127], v[204:207], v[176:179], v[112:127]
    ds_read_b64_tr_b16 v[196:197], v34 offset:8192
    ds_read_b64_tr_b16 v[198:199], v35 offset:9216
    s_waitcnt lgkmcnt(8)
    v_mfma_f32_32x32x16_bf16 v[64:79], v[208:211], v[180:183], v[64:79]
    ds_read_b64_tr_b16 v[200:201], v36 offset:8192
    ds_read_b64_tr_b16 v[202:203], v37 offset:9216
    v_mfma_f32_32x32x16_bf16 v[80:95], v[212:215], v[180:183], v[80:95]
    ds_read_b64_tr_b16 v[204:205], v38 offset:8192
    ds_read_b64_tr_b16 v[206:207], v39 offset:9216
    s_waitcnt lgkmcnt(8)
    v_mfma_f32_32x32x16_bf16 v[96:111], v[216:219], v[180:183], v[96:111]
    ds_read_b64_tr_b16 v[208:209], v32 offset:12288
    ds_read_b64_tr_b16 v[210:211], v33 offset:13312
    v_mfma_f32_32x32x16_bf16 v[112:127], v[220:223], v[180:183], v[112:127]
    ds_read_b64_tr_b16 v[212:213], v34 offset:12288
    ds_read_b64_tr_b16 v[214:215], v35 offset:13312
    s_waitcnt lgkmcnt(8)
    v_mfma_f32_32x32x16_bf16 v[64:79], v[192:195], v[184:187], v[64:79]
    ds_read_b64_tr_b16 v[216:217], v36 offset:12288
    ds_read_b64_tr_b16 v[218:219], v37 offset:13312
    v_mfma_f32_32x32x16_bf16 v[80:95], v[196:199], v[184:187], v[80:95]
    ds_read_b64_tr_b16 v[220:221], v38 offset:12288
    ds_read_b64_tr_b16 v[222:223], v39 offset:13312
    s_waitcnt lgkmcnt(8)
    v_mfma_f32_32x32x16_bf16 v[96:111], v[200:203], v[184:187], v[96:111]
    v_mfma_f32_32x32x16_bf16 v[112:127], v[204:207], v[184:187], v[112:127]
    s_waitcnt lgkmcnt(4)
    v_mfma_f32_32x32x16_bf16 v[64:79], v[208:211], v[188:191], v[64:79]
    v_mfma_f32_32x32x16_bf16 v[80:95], v[212:215], v[188:191], v[80:95]
    s_waitcnt lgkmcnt(0)
    v_mfma_f32_32x32x16_bf16 v[96:111], v[216:219], v[188:191], v[96:111]
    v_mfma_f32_32x32x16_bf16 v[112:127], v[220:223], v[188:191], v[112:127]
    s_setpc_b64 s[30:31]
L_wQ0:
    v_add_u32 v32, s8, v25
    v_xor_b32 v33, 16, v32
    v_xor_b32 v34, 64, v32
    v_xor_b32 v35, 80, v32
    v_xor_b32 v36, 128, v32
    v_xor_b32 v37, 144, v32
    v_xor_b32 v38, 192, v32
    v_xor_b32 v39, 208, v32
    ds_read_b64_tr_b16 v[192:193], v32 offset:0
    ds_read_b64_tr_b16 v[194:195], v33 offset:1024
    ds_read_b64_tr_b16 v[196:197], v34 offset:0
    ds_read_b64_tr_b16 v[198:199], v35 offset:1024
    ds_read_b64_tr_b16 v[200:201], v36 offset:0
    ds_read_b64_tr_b16 v[202:203], v37 offset:1024
    ds_read_b64_tr_b16 v[204:205], v38 offset:0
    ds_read_b64_tr_b16 v[206:207], v39 offset:1024
    ds_read_b64_tr_b16 v[208:209], v32 offset:4096
    ds_read_b64_tr_b16 v[210:211], v33 offset:5120
    ds_read_b64_tr_b16 v[212:213], v34 offset:4096
    ds_read_b64_tr_b16 v[214:215], v35 offset:5120
    s_waitcnt lgkmcnt(8)
    v_mfma_f32_32x32x16_bf16 v[64:79], v[192:195], v[128:131], v[64:79]
    ds_read_b64_tr_b16 v[216:217], v36 offset:4096
    ds_read_b64_tr_b16 v[218:219], v37 offset:5120
    buffer_load_dwordx4 v10, s[32:35], s90 offen offset:0 lds
    v_mfma_f32_32x32x16_bf16 v[80:95], v[196:199], v[128:131], v[80:95]
    ds_read_b64_tr_b16 v[220:221], v38 offset:4096
    ds_read_b64_tr_b16 v[222:223], v39 offset:5120
    buffer_load_dwordx4 v11, s[32:35], s90 offen offset:1024 lds
    s_waitcnt lgkmcnt(8)
    v_mfma_f32_32x32x16_bf16 v[96:111], v[200:203], v[128:131], v[96:111]
    ds_read_b64_tr_b16 v[192:193], v32 offset:8192
    ds_read_b64_tr_b16 v[194:195], v33 offset:9216
    buffer_load_dwordx4 v12, s[32:35], s90 offen offset:2048 lds
    v_mfma_f32_32x32x16_bf16 v[112:127], v[204:207], v[128:131], v[112:127]
    ds_read_b64_tr_b16 v[196:197], v34 offset:8192
    ds_read_b64_tr_b16 v[198:199], v35 offset:9216
    buffer_load_dwordx4 v13, s[32:35], s90 offen offset:3072 lds
    s_waitcnt lgkmcnt(8)
    v_mfma_f32_32x32x16_bf16 v[64:79], v[208:211], v[132:135], v[64:79]
    ds_read_b64_tr_b16 v[200:201], v36 offset:8192
    ds_read_b64_tr_b16 v[202:203], v37 offset:9216
    buffer_load_dwordx4 v[48:51], v14, s[36:39], s91 offen offset:0
    v_mfma_f32_32x32x16_bf16 v[80:95], v[212:215], v[132:135], v[80:95]
    ds_read_b64_tr_b16 v[204:205], v38 offset:8192
    ds_read_b64_tr_b16 v[206:207], v39 offset:9216
    buffer_load_dwordx4 v[52:55], v15, s[36:39], s91 offen offset:1024
    s_waitcnt lgkmcnt(8)
    v_mfma_f32_32x32x16_bf16 v[96:111], v[216:219], v[132:135], v[96:111]
    ds_read_b64_tr_b16 v[208:209], v32 offset:12288
    ds_read_b64_tr_b16 v[210:211], v33 offset:13312
    buffer_load_dwordx4 v[56:59], v16, s[36:39], s91 offen offset:2048
    v_mfma_f32_32x32x16_bf16 v[112:127], v[220:223], v[132:135], v[112:127]
    ds_read_b64_tr_b16 v[212:213], v34 offset:12288
    ds_read_b64_tr_b16 v[214:215], v35 offset:13312
    buffer_load_dwordx4 v[60:63], v17, s[36:39], s91 offen offset:3072
    s_waitcnt lgkmcnt(8)
    v_mfma_f32_32x32x16_bf16 v[64:79], v[192:195], v[136:139], v[64:79]
    ds_read_b64_tr_b16 v[216:217], v36 offset:12288
    ds_read_b64_tr_b16 v[218:219], v37 offset:13312
    buffer_load_dwordx4 v[224:227], v10, s[32:35], s88 offen offset:0
    v_mfma_f32_32x32x16_bf16 v[80:95], v[196:199], v[136:139], v[80:95]
    ds_read_b64_tr_b16 v[220:221], v38 offset:12288
    ds_read_b64_tr_b16 v[222:223], v39 offset:13312
    buffer_load_dwordx4 v[228:231], v11, s[32:35], s88 offen offset:1024
    s_waitcnt lgkmcnt(8)
    v_mfma_f32_32x32x16_bf16 v[96:111], v[200:203], v[136:139], v[96:111]
    buffer_load_dwordx4 v[232:235], v12, s[32:35], s88 offen offset:2048
    v_mfma_f32_32x32x16_bf16 v[112:127], v[204:207], v[136:139], v[112:127]
    buffer_load_dwordx4 v[236:239], v13, s[32:35], s88 offen offset:3072
    s_waitcnt lgkmcnt(4)
    v_mfma_f32_32x32x16_bf16 v[64:79], v[208:211], v[140:143], v[64:79]
    buffer_load_dwordx4 v[240:243], v14, s[36:39], s89 offen offset:0
    v_mfma_f32_32x32x16_bf16 v[80:95], v[212:215], v[140:143], v[80:95]
    buffer_load_dwordx4 v[244:247], v15, s[36:39], s89 offen offset:1024
    s_waitcnt lgkmcnt(0)
    v_mfma_f32_32x32x16_bf16 v[96:111], v[216:219], v[140:143], v[96:111]
    buffer_load_dwordx4 v[248:251], v16, s[36:39], s89 offen offset:2048
    v_mfma_f32_32x32x16_bf16 v[112:127], v[220:223], v[140:143], v[112:127]
    buffer_load_dwordx4 v[252:255], v17, s[36:39], s89 offen offset:3072
    s_setpc_b64 s[30:31]
L_exch:
    ds_write_b128 v46, v[96:99] offset:0
    ds_write_b128 v46, v[100:103] offset:1024
    ds_write_b128 v46, v[104:107] offset:2048
    ds_write_b128 v46, v[108:111] offset:3072
    ds_write_b128 v47, v[112:115] offset:0
    ds_write_b128 v47, v[116:119] offset:1024
    ds_write_b128 v47, v[120:123] offset:2048
    ds_write_b128 v47, v[124:127] offset:3072
    s_waitcnt lgkmcnt(0)
    s_barrier
    ds_read_b128 v[200:203], v21 offset:0
    ds_read_b128 v[204:207], v21 offset:1024
    ds_read_b128 v[208:211], v21 offset:2048
    ds_read_b128 v[212:215], v21 offset:3072
    ds_read_b128 v[216:219], v26 offset:0
    ds_read_b128 v[220:223], v26 offset:1024
    ds_read_b128 v[224:227], v26 offset:2048
    ds_read_b128 v[228:231], v26 offset:3072
    s_waitcnt lgkmcnt(7)
    v_add_f32 v64, v64, v200
    v_add_f32 v65, v65, v201
    v_add_f32 v66, v66, v202
    v_add_f32 v67, v67, v203
    s_waitcnt lgkmcnt(6)
    v_add_f32 v68, v68, v204
    v_add_f32 v69, v69, v205
    v_add_f32 v70, v70, v206
    v_add_f32 v71, v71, v207
    s_waitcnt lgkmcnt(5)
    v_add_f32 v72, v72, v208
    v_add_f32 v73, v73, v209
    v_add_f32 v74, v74, v210
    v_add_f32 v75, v75, v211
    s_waitcnt lgkmcnt(4)
    v_add_f32 v76, v76, v212
    v_add_f32 v77, v77, v213
    v_add_f32 v78, v78, v214
    v_add_f32 v79, v79, v215
    s_waitcnt lgkmcnt(3)
    v_add_f32 v80, v80, v216
    v_add_f32 v81, v81, v217
    v_add_f32 v82, v82, v218
    v_add_f32 v83, v83, v219
    s_waitcnt lgkmcnt(2)
    v_add_f32 v84, v84, v220
    v_add_f32 v85, v85, v221
    v_add_f32 v86, v86, v222
    v_add_f32 v87, v87, v223
    s_waitcnt lgkmcnt(1)
    v_add_f32 v88, v88, v224
    v_add_f32 v89, v89, v225
    v_add_f32 v90, v90, v226
    v_add_f32 v91, v91, v227
    s_waitcnt lgkmcnt(0)
    v_add_f32 v92, v92, v228
    v_add_f32 v93, v93, v229
    v_add_f32 v94, v94, v230
    v_add_f32 v95, v95, v231
    s_setpc_b64 s[30:31]
L_code_end:
    s_endpgm
.section .rodata,"a"
.p2align 6
.amdhsa_kernel concat_heads__gqa_block_cached__mha_block_cached__near_ridge_kernel
  .amdhsa_next_free_vgpr 256
  .amdhsa_next_free_sgpr 102
  .amdhsa_accum_offset 256
  .amdhsa_group_segment_fixed_size 0
  .amdhsa_kernarg_size 104
  .amdhsa_user_sgpr_count 2
  .amdhsa_user_sgpr_kernarg_segment_ptr 1
  .amdhsa_system_sgpr_workgroup_id_x 1
.end_amdhsa_kernel
```
